```python
import torch

def _softmax(x, axis=-1):
    return torch.softmax(x, dim=axis)
def _gelu(x):
    return torch.nn.functional.gelu(x, approximate="tanh")
def _silu(x):
    return torch.nn.functional.silu(x)
def _sigmoid(x):
    return torch.sigmoid(x)
def _layernorm(x, axis=-1, eps=1e-5):
    m = x.mean(dim=axis, keepdim=True)
    v = x.var(dim=axis, keepdim=True, unbiased=False)
    return (x - m) / torch.sqrt(v + eps)
def _scatter_add(tgt, idx, src, axis=0):
    return tgt.clone().index_add_(axis, idx, src)
def _segment_sum(src, seg, n):
    out = torch.zeros((n,) + src.shape[1:], dtype=src.dtype)
    return out.index_add_(0, seg, src)
def _pad(x, pw):
    flat = tuple(v for pair in reversed(pw) for v in pair)
    return torch.nn.functional.pad(x, flat)

kernel_name = 'concat_heads__sliding_local_dilated__mha_block__prompt'

def setup_inputs():

    _w = (lambda a: (lambda t: t.to(torch.bfloat16) if t.is_floating_point() else t)(torch.as_tensor(a)))
    def _A_setup():
        B, S, D = 1, 2048, 512
        return {
            "x": _w((lambda *s: torch.randn(*s, dtype=torch.bfloat16) * 0.4)(B, S, D)),
            "wqkv": _w((lambda *s: torch.randn(*s, dtype=torch.bfloat16) * 0.4)(D, 3 * D)),
            "wo": _w((lambda *s: torch.randn(*s, dtype=torch.bfloat16) * 0.05)(D, D)),
        }
    _A_in = _A_setup()

    def _B_setup():
        B, S, D, H = 1, 2048, 512, 32
        return {
            "x": _w((lambda *s: torch.randn(*s, dtype=torch.bfloat16) * 0.2)(B, S, D)),
            "wqkv": _w((lambda *s: torch.randn(*s, dtype=torch.bfloat16) * 0.4)(D, 3 * D)),
            "wo": _w((lambda *s: torch.randn(*s, dtype=torch.bfloat16) * 0.1)(D, D)),
        }
    _B_in = _B_setup()

    return {
        "A_x": _A_in["x"],
        "A_wqkv": _A_in["wqkv"],
        "A_wo": _A_in["wo"],
        "B_x": _B_in["x"],
        "B_wqkv": _B_in["wqkv"],
        "B_wo": _B_in["wo"],
    }

def reference(A_x, A_wqkv, A_wo, B_x, B_wqkv, B_wo):
    def _A_ref(x, wqkv, wo):
        B, S, D = x.shape
        H = 32; Dh = D // H
        W, dil = 8, 2
        qkv = (lambda x, *d: x.permute(*d))((x @ wqkv).reshape(B, S, 3, H, Dh), 2, 0, 3, 1, 4)
        q, k, v = qkv[0], qkv[1], qkv[2]
        scale = Dh ** -0.5
        pos = torch.arange(S)
        off = torch.arange(W) * dil
        idx = pos[:, None] - off[None, :]
        mask = idx >= 0
        idx_c = torch.where(mask, idx, 0).reshape(-1)
        kg = k[:, :, idx_c, :].reshape(B, H, S, W, Dh)
        vg = v[:, :, idx_c, :].reshape(B, H, S, W, Dh)
        logits = torch.einsum("bhsd,bhswd->bhsw", q, kg) * scale
        logits = torch.where(mask[None, None, :, :], logits, -1e9)
        attn = _softmax(logits, axis=-1)
        o = torch.einsum("bhsw,bhswd->bhsd", attn, vg)
        return (lambda x, *d: x.permute(*d))(o, 0, 2, 1, 3).reshape(B, S, D) @ wo

    def _B_ref(x, wqkv, wo):
        B, S, D = x.shape
        H = 32
        Dh = D // H
        qkv = (lambda x, *d: x.permute(*d))((x @ wqkv).reshape(B, S, 3, H, Dh), 2, 0, 3, 1, 4)
        q, k, v = qkv[0], qkv[1], qkv[2]
        scores = torch.einsum("bhqd,bhkd->bhqk", q, k) * (Dh ** -0.5)
        p = _softmax(scores, axis=-1)
        o = torch.einsum("bhqk,bhkd->bhqd", p, v)
        return (lambda x, *d: x.permute(*d))(o, 0, 2, 1, 3).reshape(B, S, D) @ wo

    a = _A_ref(A_x, A_wqkv, A_wo)
    b = _B_ref(B_x, B_wqkv, B_wo)
    return torch.concatenate([a, b], axis=-1)
```

```asm
; @launch grid=(256,1,1) block=(512,1,1) lds=163840
.amdgcn_target "amdgcn-amd-amdhsa--gfx950"
.text
.globl concat_heads__sliding_local_dilated__mha_block__prompt_kernel
.p2align 8
.type concat_heads__sliding_local_dilated__mha_block__prompt_kernel,@function
concat_heads__sliding_local_dilated__mha_block__prompt_kernel:
    s_cmp_ge_u32 s2, 256
    s_cbranch_scc1 concat_heads__sliding_local_dilated__mha_block__prompt_kernel_end
    s_load_dwordx4 s[4:7], s[0:1], 0
    s_load_dwordx4 s[8:11], s[0:1], 24
    s_load_dwordx2 s[24:25], s[0:1], 64
    s_load_dwordx2 s[44:45], s[0:1], 56
    v_and_b32 v1, 63, v0
    v_lshrrev_b32 v24, 6, v0
    s_and_b32 s26, s2, 7
    s_lshr_b32 s27, s2, 3
    v_readfirstlane_b32 s33, v24
    s_lshr_b32 s32, s26, 2
    s_and_b32 s29, s26, 3
    s_and_b32 s30, s29, 1
    s_lshl_b32 s30, s30, 3
    s_and_b32 s34, s27, 7
    s_add_u32 s30, s30, s34
    s_lshr_b32 s31, s29, 1
    s_lshl_b32 s31, s31, 2
    s_lshr_b32 s34, s27, 3
    s_add_u32 s31, s31, s34
    s_and_b32 s47, s33, 3
    s_lshl_b32 s34, s32, 3
    s_add_u32 s34, s34, s31
    s_lshl_b32 s34, s34, 4
    s_add_u32 s34, s34, s30
    s_lshl_b32 s34, s34, 7
    s_add_u32 s28, s34, 16777216
    s_waitcnt lgkmcnt(0)
    s_cmp_eq_u32 s32, 1
    s_cselect_b32 s12, s4, s8
    s_cselect_b32 s13, s5, s9
    s_cselect_b32 s16, s6, s10
    s_cselect_b32 s17, s7, s11
    s_mov_b32 s14, 2097152
    s_mov_b32 s15, 0x00020000
    s_mov_b32 s18, 1572864
    s_mov_b32 s19, 0x00020000
    s_mov_b32 s20, s24
    s_mov_b32 s21, s25
    s_mov_b32 s22, 17825792
    s_mov_b32 s23, 0x00020000
    s_mov_b32 s4, s44
    s_mov_b32 s5, s45
    s_mov_b32 s6, 256
    s_mov_b32 s7, 0x00020000
    v_lshrrev_b32 v28, 5, v1
    v_lshlrev_b32 v248, 4, v1
    v_and_b32 v24, 0x13, v1
    v_bfe_u32 v25, v1, 2, 1
    v_lshlrev_b32 v25, 3, v25
    v_bfe_u32 v26, v1, 3, 1
    v_lshlrev_b32 v26, 2, v26
    v_or3_b32 v24, v24, v25, v26
    v_lshlrev_b32 v24, 4, v24
    v_lshlrev_b32 v25, 9, v28
    v_add_u32 v249, v24, v25
    v_and_b32 v24, 15, v1
    v_lshlrev_b32 v24, 4, v24
    v_lshlrev_b32 v25, 8, v28
    v_bfe_u32 v26, v1, 4, 1
    v_lshlrev_b32 v26, 16, v26
    v_add3_u32 v250, v24, v25, v26
    s_mov_b32 s8, 0
    s_mov_b32 s9, 0
    s_cmp_lt_u32 s33, 4
    s_cbranch_scc1 concat_heads__sliding_local_dilated__mha_block__prompt_kernel_cons
    s_lshl_b32 s34, s30, 7
    s_lshl_b32 s38, s47, 5
    s_lshr_b32 s39, s47, 1
    s_lshl_b32 s39, s39, 6
    s_and_b32 s40, s47, 1
    s_add_u32 s39, s39, s40
    s_cmp_eq_u32 s32, 1
    s_cselect_b32 s38, s39, s38
    s_cselect_b32 s41, 11, 10
    s_add_u32 s34, s34, s38
    s_lshl_b32 s34, s34, 10
    v_lshrrev_b32 v24, 3, v1
    v_and_b32 v25, 7, v1
    v_lshrrev_b32 v26, 4, v1
    v_xor_b32 v25, v25, v26
    v_lshlrev_b32 v25, 4, v25
    v_lshlrev_b32 v24, s41, v24
    v_add3_u32 v2, v24, v25, s34
    s_lshl_b32 s42, 8, s41
    v_xor_b32 v25, 64, v25
    v_add3_u32 v3, v24, v25, s34
    v_add_u32 v3, s42, v3
    s_lshl_b32 s42, s42, 1
    v_add_u32 v4, s42, v2
    v_add_u32 v5, s42, v3
    v_lshrrev_b32 v24, 5, v1
    v_lshlrev_b32 v24, 2, v24
    v_bfe_u32 v25, v1, 2, 2
    v_add_u32 v24, v24, v25
    s_lshl_b32 s38, s47, 4
    v_add_u32 v24, s38, v24
    v_mul_u32_u24 v24, 3072, v24
    v_bfe_u32 v25, v1, 4, 1
    v_lshlrev_b32 v25, 6, v25
    v_and_b32 v26, 3, v1
    v_lshlrev_b32 v26, 4, v26
    v_add3_u32 v24, v24, v25, v26
    s_lshl_b32 s38, s31, 7
    v_add_u32 v6, s38, v24
    s_lshl_b32 s35, s47, 12
    s_lshl_b32 s36, s47, 11
    s_add_u32 s36, s36, 16384
    s_lshl_b32 s39, s31, 1
    s_add_u32 s39, s39, s30
    s_add_u32 s40, s39, 0
    s_and_b32 s40, s40, 7
    s_mul_i32 s41, s40, 196608
    s_lshl_b32 s40, s40, 7
    s_add_u32 m0, s35, 0
    s_nop 0
    buffer_load_dwordx4 v2, s[12:15], s40 offen lds
    s_add_u32 m0, s36, 0
    s_add_u32 s37, s41, 0
    buffer_load_dwordx4 v6, s[16:19], s37 offen lds
    s_add_u32 m0, s36, 1024
    s_add_u32 s37, s41, 24576
    buffer_load_dwordx4 v6, s[16:19], s37 offen lds
    s_add_u32 m0, s35, 1024
    s_nop 0
    buffer_load_dwordx4 v3, s[12:15], s40 offen lds
    s_add_u32 m0, s35, 2048
    s_nop 0
    buffer_load_dwordx4 v4, s[12:15], s40 offen lds
    s_add_u32 m0, s35, 3072
    s_nop 0
    buffer_load_dwordx4 v5, s[12:15], s40 offen lds
    s_add_u32 m0, s36, 8192
    s_add_u32 s37, s41, 1024
    buffer_load_dwordx4 v6, s[16:19], s37 offen lds
    s_add_u32 m0, s36, 9216
    s_add_u32 s37, s41, 25600
    buffer_load_dwordx4 v6, s[16:19], s37 offen lds
    s_add_u32 m0, s36, 16384
    s_add_u32 s37, s41, 2048
    buffer_load_dwordx4 v6, s[16:19], s37 offen lds
    s_add_u32 m0, s36, 17408
    s_add_u32 s37, s41, 26624
    buffer_load_dwordx4 v6, s[16:19], s37 offen lds
    s_add_u32 s40, s39, 1
    s_and_b32 s40, s40, 7
    s_mul_i32 s41, s40, 196608
    s_lshl_b32 s40, s40, 7
    s_add_u32 m0, s35, 40960
    s_nop 0
    buffer_load_dwordx4 v2, s[12:15], s40 offen lds
    s_add_u32 m0, s36, 40960
    s_add_u32 s37, s41, 0
    buffer_load_dwordx4 v6, s[16:19], s37 offen lds
    s_add_u32 m0, s36, 41984
    s_add_u32 s37, s41, 24576
    buffer_load_dwordx4 v6, s[16:19], s37 offen lds
    s_add_u32 m0, s35, 41984
    s_nop 0
    buffer_load_dwordx4 v3, s[12:15], s40 offen lds
    s_add_u32 m0, s35, 43008
    s_nop 0
    buffer_load_dwordx4 v4, s[12:15], s40 offen lds
    s_add_u32 m0, s35, 44032
    s_nop 0
    buffer_load_dwordx4 v5, s[12:15], s40 offen lds
    s_add_u32 m0, s36, 49152
    s_add_u32 s37, s41, 1024
    buffer_load_dwordx4 v6, s[16:19], s37 offen lds
    s_add_u32 m0, s36, 50176
    s_add_u32 s37, s41, 25600
    buffer_load_dwordx4 v6, s[16:19], s37 offen lds
    s_add_u32 m0, s36, 57344
    s_add_u32 s37, s41, 2048
    buffer_load_dwordx4 v6, s[16:19], s37 offen lds
    s_add_u32 m0, s36, 58368
    s_add_u32 s37, s41, 26624
    buffer_load_dwordx4 v6, s[16:19], s37 offen lds
    s_cmp_eq_u32 s33, 7
    s_cselect_b32 s40, s2, 1
    s_cmp_eq_u32 s40, 0
    s_cbranch_scc0 concat_heads__sliding_local_dilated__mha_block__prompt_kernel_notag
    s_memrealtime s[40:41]
    s_waitcnt lgkmcnt(0)
    s_or_b32 s40, s40, 1
    v_mov_b32 v24, s40
    v_mov_b32 v25, 0
    s_mov_b64 exec, 1
    buffer_store_dword v24, v25, s[4:7], 0 offen sc1
    s_mov_b64 exec, -1
    s_waitcnt vmcnt(0)
concat_heads__sliding_local_dilated__mha_block__prompt_kernel_notag:
    s_waitcnt vmcnt(10)
    s_barrier
    s_add_u32 s40, s39, 2
    s_and_b32 s40, s40, 7
    s_mul_i32 s41, s40, 196608
    s_lshl_b32 s40, s40, 7
    s_add_u32 m0, s35, 81920
    s_nop 0
    buffer_load_dwordx4 v2, s[12:15], s40 offen lds
    s_add_u32 m0, s36, 81920
    s_add_u32 s37, s41, 0
    buffer_load_dwordx4 v6, s[16:19], s37 offen lds
    s_add_u32 m0, s36, 82944
    s_add_u32 s37, s41, 24576
    buffer_load_dwordx4 v6, s[16:19], s37 offen lds
    s_add_u32 m0, s35, 82944
    s_nop 0
    buffer_load_dwordx4 v3, s[12:15], s40 offen lds
    s_add_u32 m0, s35, 83968
    s_nop 0
    buffer_load_dwordx4 v4, s[12:15], s40 offen lds
    s_add_u32 m0, s35, 84992
    s_nop 0
    buffer_load_dwordx4 v5, s[12:15], s40 offen lds
    s_add_u32 m0, s36, 90112
    s_add_u32 s37, s41, 1024
    buffer_load_dwordx4 v6, s[16:19], s37 offen lds
    s_add_u32 m0, s36, 91136
    s_add_u32 s37, s41, 25600
    buffer_load_dwordx4 v6, s[16:19], s37 offen lds
    s_add_u32 m0, s36, 98304
    s_add_u32 s37, s41, 2048
    buffer_load_dwordx4 v6, s[16:19], s37 offen lds
    s_add_u32 m0, s36, 99328
    s_add_u32 s37, s41, 26624
    buffer_load_dwordx4 v6, s[16:19], s37 offen lds
    s_add_u32 s40, s39, 3
    s_and_b32 s40, s40, 7
    s_mul_i32 s41, s40, 196608
    s_lshl_b32 s40, s40, 7
    s_add_u32 m0, s35, 122880
    s_nop 0
    buffer_load_dwordx4 v2, s[12:15], s40 offen lds
    s_add_u32 m0, s36, 122880
    s_add_u32 s37, s41, 0
    buffer_load_dwordx4 v6, s[16:19], s37 offen lds
    s_add_u32 m0, s36, 123904
    s_add_u32 s37, s41, 24576
    buffer_load_dwordx4 v6, s[16:19], s37 offen lds
    s_add_u32 m0, s35, 123904
    s_nop 0
    buffer_load_dwordx4 v3, s[12:15], s40 offen lds
    s_add_u32 m0, s35, 124928
    s_nop 0
    buffer_load_dwordx4 v4, s[12:15], s40 offen lds
    s_add_u32 m0, s35, 125952
    s_nop 0
    buffer_load_dwordx4 v5, s[12:15], s40 offen lds
    s_add_u32 m0, s36, 131072
    s_add_u32 s37, s41, 1024
    buffer_load_dwordx4 v6, s[16:19], s37 offen lds
    s_add_u32 m0, s36, 132096
    s_add_u32 s37, s41, 25600
    buffer_load_dwordx4 v6, s[16:19], s37 offen lds
    s_add_u32 m0, s36, 139264
    s_add_u32 s37, s41, 2048
    buffer_load_dwordx4 v6, s[16:19], s37 offen lds
    s_add_u32 m0, s36, 140288
    s_add_u32 s37, s41, 26624
    buffer_load_dwordx4 v6, s[16:19], s37 offen lds
    s_waitcnt vmcnt(20)
    s_barrier
    s_add_u32 s40, s39, 4
    s_and_b32 s40, s40, 7
    s_mul_i32 s41, s40, 196608
    s_lshl_b32 s40, s40, 7
    s_add_u32 m0, s35, 0
    s_nop 0
    buffer_load_dwordx4 v2, s[12:15], s40 offen lds
    s_add_u32 m0, s36, 0
    s_add_u32 s37, s41, 0
    buffer_load_dwordx4 v6, s[16:19], s37 offen lds
    s_add_u32 m0, s36, 1024
    s_add_u32 s37, s41, 24576
    buffer_load_dwordx4 v6, s[16:19], s37 offen lds
    s_add_u32 m0, s35, 1024
    s_nop 0
    buffer_load_dwordx4 v3, s[12:15], s40 offen lds
    s_add_u32 m0, s35, 2048
    s_nop 0
    buffer_load_dwordx4 v4, s[12:15], s40 offen lds
    s_add_u32 m0, s35, 3072
    s_nop 0
    buffer_load_dwordx4 v5, s[12:15], s40 offen lds
    s_add_u32 m0, s36, 8192
    s_add_u32 s37, s41, 1024
    buffer_load_dwordx4 v6, s[16:19], s37 offen lds
    s_add_u32 m0, s36, 9216
    s_add_u32 s37, s41, 25600
    buffer_load_dwordx4 v6, s[16:19], s37 offen lds
    s_add_u32 m0, s36, 16384
    s_add_u32 s37, s41, 2048
    buffer_load_dwordx4 v6, s[16:19], s37 offen lds
    s_add_u32 m0, s36, 17408
    s_add_u32 s37, s41, 26624
    buffer_load_dwordx4 v6, s[16:19], s37 offen lds
    s_waitcnt vmcnt(20)
    s_barrier
    s_add_u32 s40, s39, 5
    s_and_b32 s40, s40, 7
    s_mul_i32 s41, s40, 196608
    s_lshl_b32 s40, s40, 7
    s_add_u32 m0, s35, 40960
    s_nop 0
    buffer_load_dwordx4 v2, s[12:15], s40 offen lds
    s_add_u32 m0, s36, 40960
    s_add_u32 s37, s41, 0
    buffer_load_dwordx4 v6, s[16:19], s37 offen lds
    s_add_u32 m0, s36, 41984
    s_add_u32 s37, s41, 24576
    buffer_load_dwordx4 v6, s[16:19], s37 offen lds
    s_add_u32 m0, s35, 41984
    s_nop 0
    buffer_load_dwordx4 v3, s[12:15], s40 offen lds
    s_add_u32 m0, s35, 43008
    s_nop 0
    buffer_load_dwordx4 v4, s[12:15], s40 offen lds
    s_add_u32 m0, s35, 44032
    s_nop 0
    buffer_load_dwordx4 v5, s[12:15], s40 offen lds
    s_add_u32 m0, s36, 49152
    s_add_u32 s37, s41, 1024
    buffer_load_dwordx4 v6, s[16:19], s37 offen lds
    s_add_u32 m0, s36, 50176
    s_add_u32 s37, s41, 25600
    buffer_load_dwordx4 v6, s[16:19], s37 offen lds
    s_add_u32 m0, s36, 57344
    s_add_u32 s37, s41, 2048
    buffer_load_dwordx4 v6, s[16:19], s37 offen lds
    s_add_u32 m0, s36, 58368
    s_add_u32 s37, s41, 26624
    buffer_load_dwordx4 v6, s[16:19], s37 offen lds
    s_waitcnt vmcnt(20)
    s_barrier
    s_add_u32 s40, s39, 6
    s_and_b32 s40, s40, 7
    s_mul_i32 s41, s40, 196608
    s_lshl_b32 s40, s40, 7
    s_add_u32 m0, s35, 81920
    s_nop 0
    buffer_load_dwordx4 v2, s[12:15], s40 offen lds
    s_add_u32 m0, s36, 81920
    s_add_u32 s37, s41, 0
    buffer_load_dwordx4 v6, s[16:19], s37 offen lds
    s_add_u32 m0, s36, 82944
    s_add_u32 s37, s41, 24576
    buffer_load_dwordx4 v6, s[16:19], s37 offen lds
    s_add_u32 m0, s35, 82944
    s_nop 0
    buffer_load_dwordx4 v3, s[12:15], s40 offen lds
    s_add_u32 m0, s35, 83968
    s_nop 0
    buffer_load_dwordx4 v4, s[12:15], s40 offen lds
    s_add_u32 m0, s35, 84992
    s_nop 0
    buffer_load_dwordx4 v5, s[12:15], s40 offen lds
    s_add_u32 m0, s36, 90112
    s_add_u32 s37, s41, 1024
    buffer_load_dwordx4 v6, s[16:19], s37 offen lds
    s_add_u32 m0, s36, 91136
    s_add_u32 s37, s41, 25600
    buffer_load_dwordx4 v6, s[16:19], s37 offen lds
    s_add_u32 m0, s36, 98304
    s_add_u32 s37, s41, 2048
    buffer_load_dwordx4 v6, s[16:19], s37 offen lds
    s_add_u32 m0, s36, 99328
    s_add_u32 s37, s41, 26624
    buffer_load_dwordx4 v6, s[16:19], s37 offen lds
    s_waitcnt vmcnt(20)
    s_barrier
    s_add_u32 s40, s39, 7
    s_and_b32 s40, s40, 7
    s_mul_i32 s41, s40, 196608
    s_lshl_b32 s40, s40, 7
    s_add_u32 m0, s35, 122880
    s_nop 0
    buffer_load_dwordx4 v2, s[12:15], s40 offen lds
    s_add_u32 m0, s36, 122880
    s_add_u32 s37, s41, 0
    buffer_load_dwordx4 v6, s[16:19], s37 offen lds
    s_add_u32 m0, s36, 123904
    s_add_u32 s37, s41, 24576
    buffer_load_dwordx4 v6, s[16:19], s37 offen lds
    s_add_u32 m0, s35, 123904
    s_nop 0
    buffer_load_dwordx4 v3, s[12:15], s40 offen lds
    s_add_u32 m0, s35, 124928
    s_nop 0
    buffer_load_dwordx4 v4, s[12:15], s40 offen lds
    s_add_u32 m0, s35, 125952
    s_nop 0
    buffer_load_dwordx4 v5, s[12:15], s40 offen lds
    s_add_u32 m0, s36, 131072
    s_add_u32 s37, s41, 1024
    buffer_load_dwordx4 v6, s[16:19], s37 offen lds
    s_add_u32 m0, s36, 132096
    s_add_u32 s37, s41, 25600
    buffer_load_dwordx4 v6, s[16:19], s37 offen lds
    s_add_u32 m0, s36, 139264
    s_add_u32 s37, s41, 2048
    buffer_load_dwordx4 v6, s[16:19], s37 offen lds
    s_add_u32 m0, s36, 140288
    s_add_u32 s37, s41, 26624
    buffer_load_dwordx4 v6, s[16:19], s37 offen lds
    s_waitcnt vmcnt(20)
    s_barrier
    s_waitcnt vmcnt(10)
    s_barrier
    s_waitcnt vmcnt(0)
    s_barrier
concat_heads__sliding_local_dilated__mha_block__prompt_kernel_prodj:
    s_cmp_eq_u32 s33, 7
    s_cbranch_scc0 concat_heads__sliding_local_dilated__mha_block__prompt_kernel_join
    v_mov_b32 v25, 0
    s_mov_b32 s51, 0
concat_heads__sliding_local_dilated__mha_block__prompt_kernel_poll1:
    buffer_load_dword v24, v25, s[4:7], 0 offen sc1
concat_heads__sliding_local_dilated__mha_block__prompt_kernel_poll1_chk:
    s_waitcnt vmcnt(0)
    v_cmp_eq_u32 vcc, 0, v24
    s_cbranch_vccz concat_heads__sliding_local_dilated__mha_block__prompt_kernel_poll1_ok
    s_add_u32 s51, s51, 1
    s_cmp_lt_u32 s51, 32768
    s_cbranch_scc1 concat_heads__sliding_local_dilated__mha_block__prompt_kernel_poll1
concat_heads__sliding_local_dilated__mha_block__prompt_kernel_poll1_ok:
    v_readfirstlane_b32 s3, v24
    s_branch concat_heads__sliding_local_dilated__mha_block__prompt_kernel_join
concat_heads__sliding_local_dilated__mha_block__prompt_kernel_cons:
    s_and_b32 s43, s47, 1
    s_lshr_b32 s44, s47, 1
    v_and_b32 v24, 31, v1
    v_lshlrev_b32 v25, 7, v24
    s_lshl_b32 s38, s43, 13
    v_add_u32 v25, s38, v25
    v_bfe_u32 v26, v1, 1, 3
    v_lshrrev_b32 v27, 5, v1
    v_xor_b32 v26, v26, v27
    v_lshlrev_b32 v26, 4, v26
    v_xor_b32 v28, 0, v26
    v_add_u32 v8, v25, v28
    v_add_u32 v12, 81920, v8
    v_xor_b32 v28, 32, v26
    v_add_u32 v9, v25, v28
    v_add_u32 v13, 81920, v9
    v_xor_b32 v28, 64, v26
    v_add_u32 v10, v25, v28
    v_add_u32 v14, 81920, v10
    v_xor_b32 v28, 96, v26
    v_add_u32 v11, v25, v28
    v_add_u32 v15, 81920, v11
    v_lshlrev_b32 v24, 10, v27
    v_bfe_u32 v25, v1, 2, 2
    v_lshlrev_b32 v25, 6, v25
    v_bfe_u32 v26, v1, 4, 1
    v_lshlrev_b32 v26, 5, v26
    v_add3_u32 v24, v24, v25, v26
    v_and_b32 v25, 1, v1
    v_lshlrev_b32 v25, 4, v25
    v_bfe_u32 v26, v1, 1, 1
    v_lshlrev_b32 v26, 3, v26
    v_add3_u32 v24, v24, v25, v26
    s_lshl_b32 s38, s44, 8
    s_add_u32 s38, s38, 16384
    v_add_u32 v16, s38, v24
    v_add_u32 v17, 40960, v16
    v_add_u32 v18, 81920, v16
    v_add_u32 v19, 122880, v16
    s_lshl_b32 s45, s31, 2
    s_lshl_b32 s38, s44, 1
    s_add_u32 s45, s45, s38
    s_lshl_b32 s45, s45, 16
    s_lshl_b32 s38, s30, 2
    s_lshl_b32 s39, s43, 1
    s_add_u32 s38, s38, s39
    s_lshl_b32 s39, s30, 1
    s_add_u32 s39, s39, s43
    s_cmp_eq_u32 s32, 1
    s_cselect_b32 s38, s39, s38
    s_cselect_b32 s46, 15, 10
    s_cselect_b32 s39, 0, 8388608
    s_lshl_b32 s9, 1, s46
    s_lshl_b32 s38, s38, 10
    s_add_u32 s45, s45, s38
    s_add_u32 s8, s45, s39
    s_mov_b32 s48, 0x3eb8aa3b
    s_mov_b32 s49, 0x3eb8aa3b
    s_barrier
    ds_read_b64_tr_b16 v[40:41], v16 offset:0
    ds_read_b64_tr_b16 v[42:43], v16 offset:512
    ds_read_b128 v[32:35], v8 offset:0
    ds_read_b128 v[36:39], v8 offset:4096
    ds_read_b64_tr_b16 v[44:45], v16 offset:8192
    ds_read_b64_tr_b16 v[46:47], v16 offset:8704
    ds_read_b64_tr_b16 v[48:49], v16 offset:16384
    ds_read_b64_tr_b16 v[50:51], v16 offset:16896
    s_waitcnt lgkmcnt(5)
    v_mfma_f32_32x32x16_bf16 v[72:87], v[40:43], v[32:35], 0
    ds_read_b64_tr_b16 v[60:61], v16 offset:2048
    ds_read_b64_tr_b16 v[62:63], v16 offset:2560
    s_waitcnt lgkmcnt(6)
    v_mfma_f32_32x32x16_bf16 v[88:103], v[40:43], v[36:39], 0
    ds_read_b128 v[52:55], v9 offset:0
    ds_read_b128 v[56:59], v9 offset:4096
    s_waitcnt lgkmcnt(6)
    v_mfma_f32_32x32x16_bf16 v[104:119], v[44:47], v[32:35], 0
    ds_read_b64_tr_b16 v[64:65], v16 offset:10240
    ds_read_b64_tr_b16 v[66:67], v16 offset:10752
    v_mfma_f32_32x32x16_bf16 v[120:135], v[44:47], v[36:39], 0
    ds_read_b64_tr_b16 v[68:69], v16 offset:18432
    ds_read_b64_tr_b16 v[70:71], v16 offset:18944
    s_waitcnt lgkmcnt(8)
    v_mfma_f32_32x32x16_bf16 v[136:151], v[32:35], v[48:51], 0
    v_mfma_f32_32x32x16_bf16 v[152:167], v[36:39], v[48:51], 0
    s_waitcnt lgkmcnt(5)
    v_mfma_f32_32x32x16_bf16 v[72:87], v[60:63], v[52:55], v[72:87]
    ds_read_b64_tr_b16 v[40:41], v16 offset:4096
    ds_read_b64_tr_b16 v[42:43], v16 offset:4608
    s_waitcnt lgkmcnt(6)
    v_mfma_f32_32x32x16_bf16 v[88:103], v[60:63], v[56:59], v[88:103]
    ds_read_b128 v[32:35], v10 offset:0
    ds_read_b128 v[36:39], v10 offset:4096
    s_waitcnt lgkmcnt(6)
    v_mfma_f32_32x32x16_bf16 v[104:119], v[64:67], v[52:55], v[104:119]
    ds_read_b64_tr_b16 v[44:45], v16 offset:12288
    ds_read_b64_tr_b16 v[46:47], v16 offset:12800
    v_mfma_f32_32x32x16_bf16 v[120:135], v[64:67], v[56:59], v[120:135]
    ds_read_b64_tr_b16 v[48:49], v16 offset:20480
    ds_read_b64_tr_b16 v[50:51], v16 offset:20992
    s_waitcnt lgkmcnt(8)
    v_mfma_f32_32x32x16_bf16 v[136:151], v[52:55], v[68:71], v[136:151]
    v_mfma_f32_32x32x16_bf16 v[152:167], v[56:59], v[68:71], v[152:167]
    s_waitcnt lgkmcnt(5)
    v_mfma_f32_32x32x16_bf16 v[72:87], v[40:43], v[32:35], v[72:87]
    ds_read_b64_tr_b16 v[60:61], v16 offset:6144
    ds_read_b64_tr_b16 v[62:63], v16 offset:6656
    s_waitcnt lgkmcnt(6)
    v_mfma_f32_32x32x16_bf16 v[88:103], v[40:43], v[36:39], v[88:103]
    ds_read_b128 v[52:55], v11 offset:0
    ds_read_b128 v[56:59], v11 offset:4096
    s_waitcnt lgkmcnt(6)
    v_mfma_f32_32x32x16_bf16 v[104:119], v[44:47], v[32:35], v[104:119]
    ds_read_b64_tr_b16 v[64:65], v16 offset:14336
    ds_read_b64_tr_b16 v[66:67], v16 offset:14848
    v_mfma_f32_32x32x16_bf16 v[120:135], v[44:47], v[36:39], v[120:135]
    ds_read_b64_tr_b16 v[68:69], v16 offset:22528
    ds_read_b64_tr_b16 v[70:71], v16 offset:23040
    s_waitcnt lgkmcnt(8)
    v_mfma_f32_32x32x16_bf16 v[136:151], v[32:35], v[48:51], v[136:151]
    v_mfma_f32_32x32x16_bf16 v[152:167], v[36:39], v[48:51], v[152:167]
    s_waitcnt lgkmcnt(0)
    v_mfma_f32_32x32x16_bf16 v[72:87], v[60:63], v[52:55], v[72:87]
    v_mfma_f32_32x32x16_bf16 v[88:103], v[60:63], v[56:59], v[88:103]
    s_barrier
    ds_read_b64_tr_b16 v[40:41], v17 offset:0
    ds_read_b64_tr_b16 v[42:43], v17 offset:512
    ds_read_b128 v[32:35], v8 offset:40960
    ds_read_b128 v[36:39], v8 offset:45056
    v_mfma_f32_32x32x16_bf16 v[104:119], v[64:67], v[52:55], v[104:119]
    ds_read_b64_tr_b16 v[44:45], v17 offset:8192
    ds_read_b64_tr_b16 v[46:47], v17 offset:8704
    ds_read_b64_tr_b16 v[48:49], v17 offset:16384
    ds_read_b64_tr_b16 v[50:51], v17 offset:16896
    v_mfma_f32_32x32x16_bf16 v[120:135], v[64:67], v[56:59], v[120:135]
    v_mfma_f32_32x32x16_bf16 v[136:151], v[52:55], v[68:71], v[136:151]
    v_mfma_f32_32x32x16_bf16 v[152:167], v[56:59], v[68:71], v[152:167]
    s_waitcnt lgkmcnt(5)
    v_mfma_f32_32x32x16_bf16 v[72:87], v[40:43], v[32:35], v[72:87]
    ds_read_b64_tr_b16 v[60:61], v17 offset:2048
    ds_read_b64_tr_b16 v[62:63], v17 offset:2560
    s_waitcnt lgkmcnt(6)
    v_mfma_f32_32x32x16_bf16 v[88:103], v[40:43], v[36:39], v[88:103]
    ds_read_b128 v[52:55], v9 offset:40960
    ds_read_b128 v[56:59], v9 offset:45056
    s_waitcnt lgkmcnt(6)
    v_mfma_f32_32x32x16_bf16 v[104:119], v[44:47], v[32:35], v[104:119]
    ds_read_b64_tr_b16 v[64:65], v17 offset:10240
    ds_read_b64_tr_b16 v[66:67], v17 offset:10752
    v_mfma_f32_32x32x16_bf16 v[120:135], v[44:47], v[36:39], v[120:135]
    ds_read_b64_tr_b16 v[68:69], v17 offset:18432
    ds_read_b64_tr_b16 v[70:71], v17 offset:18944
    s_waitcnt lgkmcnt(8)
    v_mfma_f32_32x32x16_bf16 v[136:151], v[32:35], v[48:51], v[136:151]
    v_mfma_f32_32x32x16_bf16 v[152:167], v[36:39], v[48:51], v[152:167]
    s_waitcnt lgkmcnt(5)
    v_mfma_f32_32x32x16_bf16 v[72:87], v[60:63], v[52:55], v[72:87]
    ds_read_b64_tr_b16 v[40:41], v17 offset:4096
    ds_read_b64_tr_b16 v[42:43], v17 offset:4608
    s_waitcnt lgkmcnt(6)
    v_mfma_f32_32x32x16_bf16 v[88:103], v[60:63], v[56:59], v[88:103]
    ds_read_b128 v[32:35], v10 offset:40960
    ds_read_b128 v[36:39], v10 offset:45056
    s_waitcnt lgkmcnt(6)
    v_mfma_f32_32x32x16_bf16 v[104:119], v[64:67], v[52:55], v[104:119]
    ds_read_b64_tr_b16 v[44:45], v17 offset:12288
    ds_read_b64_tr_b16 v[46:47], v17 offset:12800
    v_mfma_f32_32x32x16_bf16 v[120:135], v[64:67], v[56:59], v[120:135]
    ds_read_b64_tr_b16 v[48:49], v17 offset:20480
    ds_read_b64_tr_b16 v[50:51], v17 offset:20992
    s_waitcnt lgkmcnt(8)
    v_mfma_f32_32x32x16_bf16 v[136:151], v[52:55], v[68:71], v[136:151]
    v_mfma_f32_32x32x16_bf16 v[152:167], v[56:59], v[68:71], v[152:167]
    s_waitcnt lgkmcnt(5)
    v_mfma_f32_32x32x16_bf16 v[72:87], v[40:43], v[32:35], v[72:87]
    ds_read_b64_tr_b16 v[60:61], v17 offset:6144
    ds_read_b64_tr_b16 v[62:63], v17 offset:6656
    s_waitcnt lgkmcnt(6)
    v_mfma_f32_32x32x16_bf16 v[88:103], v[40:43], v[36:39], v[88:103]
    ds_read_b128 v[52:55], v11 offset:40960
    ds_read_b128 v[56:59], v11 offset:45056
    s_waitcnt lgkmcnt(6)
    v_mfma_f32_32x32x16_bf16 v[104:119], v[44:47], v[32:35], v[104:119]
    ds_read_b64_tr_b16 v[64:65], v17 offset:14336
    ds_read_b64_tr_b16 v[66:67], v17 offset:14848
    v_mfma_f32_32x32x16_bf16 v[120:135], v[44:47], v[36:39], v[120:135]
    ds_read_b64_tr_b16 v[68:69], v17 offset:22528
    ds_read_b64_tr_b16 v[70:71], v17 offset:23040
    s_waitcnt lgkmcnt(8)
    v_mfma_f32_32x32x16_bf16 v[136:151], v[32:35], v[48:51], v[136:151]
    v_mfma_f32_32x32x16_bf16 v[152:167], v[36:39], v[48:51], v[152:167]
    s_waitcnt lgkmcnt(0)
    v_mfma_f32_32x32x16_bf16 v[72:87], v[60:63], v[52:55], v[72:87]
    v_mfma_f32_32x32x16_bf16 v[88:103], v[60:63], v[56:59], v[88:103]
    s_barrier
    ds_read_b64_tr_b16 v[40:41], v18 offset:0
    ds_read_b64_tr_b16 v[42:43], v18 offset:512
    ds_read_b128 v[32:35], v12 offset:0
    ds_read_b128 v[36:39], v12 offset:4096
    v_mfma_f32_32x32x16_bf16 v[104:119], v[64:67], v[52:55], v[104:119]
    ds_read_b64_tr_b16 v[44:45], v18 offset:8192
    ds_read_b64_tr_b16 v[46:47], v18 offset:8704
    ds_read_b64_tr_b16 v[48:49], v18 offset:16384
    ds_read_b64_tr_b16 v[50:51], v18 offset:16896
    v_mfma_f32_32x32x16_bf16 v[120:135], v[64:67], v[56:59], v[120:135]
    v_mfma_f32_32x32x16_bf16 v[136:151], v[52:55], v[68:71], v[136:151]
    v_mfma_f32_32x32x16_bf16 v[152:167], v[56:59], v[68:71], v[152:167]
    s_waitcnt lgkmcnt(5)
    v_mfma_f32_32x32x16_bf16 v[72:87], v[40:43], v[32:35], v[72:87]
    ds_read_b64_tr_b16 v[60:61], v18 offset:2048
    ds_read_b64_tr_b16 v[62:63], v18 offset:2560
    s_waitcnt lgkmcnt(6)
    v_mfma_f32_32x32x16_bf16 v[88:103], v[40:43], v[36:39], v[88:103]
    ds_read_b128 v[52:55], v13 offset:0
    ds_read_b128 v[56:59], v13 offset:4096
    s_waitcnt lgkmcnt(6)
    v_mfma_f32_32x32x16_bf16 v[104:119], v[44:47], v[32:35], v[104:119]
    ds_read_b64_tr_b16 v[64:65], v18 offset:10240
    ds_read_b64_tr_b16 v[66:67], v18 offset:10752
    v_mfma_f32_32x32x16_bf16 v[120:135], v[44:47], v[36:39], v[120:135]
    ds_read_b64_tr_b16 v[68:69], v18 offset:18432
    ds_read_b64_tr_b16 v[70:71], v18 offset:18944
    s_waitcnt lgkmcnt(8)
    v_mfma_f32_32x32x16_bf16 v[136:151], v[32:35], v[48:51], v[136:151]
    v_mfma_f32_32x32x16_bf16 v[152:167], v[36:39], v[48:51], v[152:167]
    s_waitcnt lgkmcnt(5)
    v_mfma_f32_32x32x16_bf16 v[72:87], v[60:63], v[52:55], v[72:87]
    ds_read_b64_tr_b16 v[40:41], v18 offset:4096
    ds_read_b64_tr_b16 v[42:43], v18 offset:4608
    s_waitcnt lgkmcnt(6)
    v_mfma_f32_32x32x16_bf16 v[88:103], v[60:63], v[56:59], v[88:103]
    ds_read_b128 v[32:35], v14 offset:0
    ds_read_b128 v[36:39], v14 offset:4096
    s_waitcnt lgkmcnt(6)
    v_mfma_f32_32x32x16_bf16 v[104:119], v[64:67], v[52:55], v[104:119]
    ds_read_b64_tr_b16 v[44:45], v18 offset:12288
    ds_read_b64_tr_b16 v[46:47], v18 offset:12800
    v_mfma_f32_32x32x16_bf16 v[120:135], v[64:67], v[56:59], v[120:135]
    ds_read_b64_tr_b16 v[48:49], v18 offset:20480
    ds_read_b64_tr_b16 v[50:51], v18 offset:20992
    s_waitcnt lgkmcnt(8)
    v_mfma_f32_32x32x16_bf16 v[136:151], v[52:55], v[68:71], v[136:151]
    v_mfma_f32_32x32x16_bf16 v[152:167], v[56:59], v[68:71], v[152:167]
    s_waitcnt lgkmcnt(5)
    v_mfma_f32_32x32x16_bf16 v[72:87], v[40:43], v[32:35], v[72:87]
    ds_read_b64_tr_b16 v[60:61], v18 offset:6144
    ds_read_b64_tr_b16 v[62:63], v18 offset:6656
    s_waitcnt lgkmcnt(6)
    v_mfma_f32_32x32x16_bf16 v[88:103], v[40:43], v[36:39], v[88:103]
    ds_read_b128 v[52:55], v15 offset:0
    ds_read_b128 v[56:59], v15 offset:4096
    s_waitcnt lgkmcnt(6)
    v_mfma_f32_32x32x16_bf16 v[104:119], v[44:47], v[32:35], v[104:119]
    ds_read_b64_tr_b16 v[64:65], v18 offset:14336
    ds_read_b64_tr_b16 v[66:67], v18 offset:14848
    v_mfma_f32_32x32x16_bf16 v[120:135], v[44:47], v[36:39], v[120:135]
    ds_read_b64_tr_b16 v[68:69], v18 offset:22528
    ds_read_b64_tr_b16 v[70:71], v18 offset:23040
    s_waitcnt lgkmcnt(8)
    v_mfma_f32_32x32x16_bf16 v[136:151], v[32:35], v[48:51], v[136:151]
    v_mfma_f32_32x32x16_bf16 v[152:167], v[36:39], v[48:51], v[152:167]
    s_waitcnt lgkmcnt(0)
    v_mfma_f32_32x32x16_bf16 v[72:87], v[60:63], v[52:55], v[72:87]
    v_mfma_f32_32x32x16_bf16 v[88:103], v[60:63], v[56:59], v[88:103]
    s_barrier
    ds_read_b64_tr_b16 v[40:41], v19 offset:0
    ds_read_b64_tr_b16 v[42:43], v19 offset:512
    ds_read_b128 v[32:35], v12 offset:40960
    ds_read_b128 v[36:39], v12 offset:45056
    v_mfma_f32_32x32x16_bf16 v[104:119], v[64:67], v[52:55], v[104:119]
    ds_read_b64_tr_b16 v[44:45], v19 offset:8192
    ds_read_b64_tr_b16 v[46:47], v19 offset:8704
    ds_read_b64_tr_b16 v[48:49], v19 offset:16384
    ds_read_b64_tr_b16 v[50:51], v19 offset:16896
    v_mfma_f32_32x32x16_bf16 v[120:135], v[64:67], v[56:59], v[120:135]
    v_mfma_f32_32x32x16_bf16 v[136:151], v[52:55], v[68:71], v[136:151]
    v_mfma_f32_32x32x16_bf16 v[152:167], v[56:59], v[68:71], v[152:167]
    s_waitcnt lgkmcnt(5)
    v_mfma_f32_32x32x16_bf16 v[72:87], v[40:43], v[32:35], v[72:87]
    ds_read_b64_tr_b16 v[60:61], v19 offset:2048
    ds_read_b64_tr_b16 v[62:63], v19 offset:2560
    s_waitcnt lgkmcnt(6)
    v_mfma_f32_32x32x16_bf16 v[88:103], v[40:43], v[36:39], v[88:103]
    ds_read_b128 v[52:55], v13 offset:40960
    ds_read_b128 v[56:59], v13 offset:45056
    s_waitcnt lgkmcnt(6)
    v_mfma_f32_32x32x16_bf16 v[104:119], v[44:47], v[32:35], v[104:119]
    ds_read_b64_tr_b16 v[64:65], v19 offset:10240
    ds_read_b64_tr_b16 v[66:67], v19 offset:10752
    v_mfma_f32_32x32x16_bf16 v[120:135], v[44:47], v[36:39], v[120:135]
    ds_read_b64_tr_b16 v[68:69], v19 offset:18432
    ds_read_b64_tr_b16 v[70:71], v19 offset:18944
    s_waitcnt lgkmcnt(8)
    v_mfma_f32_32x32x16_bf16 v[136:151], v[32:35], v[48:51], v[136:151]
    v_mfma_f32_32x32x16_bf16 v[152:167], v[36:39], v[48:51], v[152:167]
    s_waitcnt lgkmcnt(5)
    v_mfma_f32_32x32x16_bf16 v[72:87], v[60:63], v[52:55], v[72:87]
    ds_read_b64_tr_b16 v[40:41], v19 offset:4096
    ds_read_b64_tr_b16 v[42:43], v19 offset:4608
    s_waitcnt lgkmcnt(6)
    v_mfma_f32_32x32x16_bf16 v[88:103], v[60:63], v[56:59], v[88:103]
    ds_read_b128 v[32:35], v14 offset:40960
    ds_read_b128 v[36:39], v14 offset:45056
    s_waitcnt lgkmcnt(6)
    v_mfma_f32_32x32x16_bf16 v[104:119], v[64:67], v[52:55], v[104:119]
    ds_read_b64_tr_b16 v[44:45], v19 offset:12288
    ds_read_b64_tr_b16 v[46:47], v19 offset:12800
    v_mfma_f32_32x32x16_bf16 v[120:135], v[64:67], v[56:59], v[120:135]
    ds_read_b64_tr_b16 v[48:49], v19 offset:20480
    ds_read_b64_tr_b16 v[50:51], v19 offset:20992
    s_waitcnt lgkmcnt(8)
    v_mfma_f32_32x32x16_bf16 v[136:151], v[52:55], v[68:71], v[136:151]
    v_mfma_f32_32x32x16_bf16 v[152:167], v[56:59], v[68:71], v[152:167]
    s_waitcnt lgkmcnt(5)
    v_mfma_f32_32x32x16_bf16 v[72:87], v[40:43], v[32:35], v[72:87]
    ds_read_b64_tr_b16 v[60:61], v19 offset:6144
    ds_read_b64_tr_b16 v[62:63], v19 offset:6656
    s_waitcnt lgkmcnt(6)
    v_mfma_f32_32x32x16_bf16 v[88:103], v[40:43], v[36:39], v[88:103]
    ds_read_b128 v[52:55], v15 offset:40960
    ds_read_b128 v[56:59], v15 offset:45056
    s_waitcnt lgkmcnt(6)
    v_mfma_f32_32x32x16_bf16 v[104:119], v[44:47], v[32:35], v[104:119]
    ds_read_b64_tr_b16 v[64:65], v19 offset:14336
    ds_read_b64_tr_b16 v[66:67], v19 offset:14848
    v_mfma_f32_32x32x16_bf16 v[120:135], v[44:47], v[36:39], v[120:135]
    ds_read_b64_tr_b16 v[68:69], v19 offset:22528
    ds_read_b64_tr_b16 v[70:71], v19 offset:23040
    s_waitcnt lgkmcnt(8)
    v_mfma_f32_32x32x16_bf16 v[136:151], v[32:35], v[48:51], v[136:151]
    v_mfma_f32_32x32x16_bf16 v[152:167], v[36:39], v[48:51], v[152:167]
    s_waitcnt lgkmcnt(0)
    v_mfma_f32_32x32x16_bf16 v[72:87], v[60:63], v[52:55], v[72:87]
    v_mfma_f32_32x32x16_bf16 v[88:103], v[60:63], v[56:59], v[88:103]
    s_barrier
    ds_read_b64_tr_b16 v[40:41], v16 offset:0
    ds_read_b64_tr_b16 v[42:43], v16 offset:512
    ds_read_b128 v[32:35], v8 offset:0
    ds_read_b128 v[36:39], v8 offset:4096
    v_mfma_f32_32x32x16_bf16 v[104:119], v[64:67], v[52:55], v[104:119]
    ds_read_b64_tr_b16 v[44:45], v16 offset:8192
    ds_read_b64_tr_b16 v[46:47], v16 offset:8704
    ds_read_b64_tr_b16 v[48:49], v16 offset:16384
    ds_read_b64_tr_b16 v[50:51], v16 offset:16896
    v_mfma_f32_32x32x16_bf16 v[120:135], v[64:67], v[56:59], v[120:135]
    v_mfma_f32_32x32x16_bf16 v[136:151], v[52:55], v[68:71], v[136:151]
    v_mfma_f32_32x32x16_bf16 v[152:167], v[56:59], v[68:71], v[152:167]
    s_waitcnt lgkmcnt(5)
    v_mfma_f32_32x32x16_bf16 v[72:87], v[40:43], v[32:35], v[72:87]
    ds_read_b64_tr_b16 v[60:61], v16 offset:2048
    ds_read_b64_tr_b16 v[62:63], v16 offset:2560
    s_waitcnt lgkmcnt(6)
    v_mfma_f32_32x32x16_bf16 v[88:103], v[40:43], v[36:39], v[88:103]
    ds_read_b128 v[52:55], v9 offset:0
    ds_read_b128 v[56:59], v9 offset:4096
    s_waitcnt lgkmcnt(6)
    v_mfma_f32_32x32x16_bf16 v[104:119], v[44:47], v[32:35], v[104:119]
    ds_read_b64_tr_b16 v[64:65], v16 offset:10240
    ds_read_b64_tr_b16 v[66:67], v16 offset:10752
    v_mfma_f32_32x32x16_bf16 v[120:135], v[44:47], v[36:39], v[120:135]
    ds_read_b64_tr_b16 v[68:69], v16 offset:18432
    ds_read_b64_tr_b16 v[70:71], v16 offset:18944
    s_waitcnt lgkmcnt(8)
    v_mfma_f32_32x32x16_bf16 v[136:151], v[32:35], v[48:51], v[136:151]
    v_mfma_f32_32x32x16_bf16 v[152:167], v[36:39], v[48:51], v[152:167]
    s_waitcnt lgkmcnt(5)
    v_mfma_f32_32x32x16_bf16 v[72:87], v[60:63], v[52:55], v[72:87]
    ds_read_b64_tr_b16 v[40:41], v16 offset:4096
    ds_read_b64_tr_b16 v[42:43], v16 offset:4608
    s_waitcnt lgkmcnt(6)
    v_mfma_f32_32x32x16_bf16 v[88:103], v[60:63], v[56:59], v[88:103]
    ds_read_b128 v[32:35], v10 offset:0
    ds_read_b128 v[36:39], v10 offset:4096
    s_waitcnt lgkmcnt(6)
    v_mfma_f32_32x32x16_bf16 v[104:119], v[64:67], v[52:55], v[104:119]
    ds_read_b64_tr_b16 v[44:45], v16 offset:12288
    ds_read_b64_tr_b16 v[46:47], v16 offset:12800
    v_mfma_f32_32x32x16_bf16 v[120:135], v[64:67], v[56:59], v[120:135]
    ds_read_b64_tr_b16 v[48:49], v16 offset:20480
    ds_read_b64_tr_b16 v[50:51], v16 offset:20992
    s_waitcnt lgkmcnt(8)
    v_mfma_f32_32x32x16_bf16 v[136:151], v[52:55], v[68:71], v[136:151]
    v_mfma_f32_32x32x16_bf16 v[152:167], v[56:59], v[68:71], v[152:167]
    s_waitcnt lgkmcnt(5)
    v_mfma_f32_32x32x16_bf16 v[72:87], v[40:43], v[32:35], v[72:87]
    ds_read_b64_tr_b16 v[60:61], v16 offset:6144
    ds_read_b64_tr_b16 v[62:63], v16 offset:6656
    s_waitcnt lgkmcnt(6)
    v_mfma_f32_32x32x16_bf16 v[88:103], v[40:43], v[36:39], v[88:103]
    ds_read_b128 v[52:55], v11 offset:0
    ds_read_b128 v[56:59], v11 offset:4096
    s_waitcnt lgkmcnt(6)
    v_mfma_f32_32x32x16_bf16 v[104:119], v[44:47], v[32:35], v[104:119]
    ds_read_b64_tr_b16 v[64:65], v16 offset:14336
    ds_read_b64_tr_b16 v[66:67], v16 offset:14848
    v_mfma_f32_32x32x16_bf16 v[120:135], v[44:47], v[36:39], v[120:135]
    ds_read_b64_tr_b16 v[68:69], v16 offset:22528
    ds_read_b64_tr_b16 v[70:71], v16 offset:23040
    s_waitcnt lgkmcnt(8)
    v_mfma_f32_32x32x16_bf16 v[136:151], v[32:35], v[48:51], v[136:151]
    v_mfma_f32_32x32x16_bf16 v[152:167], v[36:39], v[48:51], v[152:167]
    s_waitcnt lgkmcnt(0)
    v_mfma_f32_32x32x16_bf16 v[72:87], v[60:63], v[52:55], v[72:87]
    v_mfma_f32_32x32x16_bf16 v[88:103], v[60:63], v[56:59], v[88:103]
    s_barrier
    ds_read_b64_tr_b16 v[40:41], v17 offset:0
    ds_read_b64_tr_b16 v[42:43], v17 offset:512
    ds_read_b128 v[32:35], v8 offset:40960
    ds_read_b128 v[36:39], v8 offset:45056
    v_mfma_f32_32x32x16_bf16 v[104:119], v[64:67], v[52:55], v[104:119]
    ds_read_b64_tr_b16 v[44:45], v17 offset:8192
    ds_read_b64_tr_b16 v[46:47], v17 offset:8704
    ds_read_b64_tr_b16 v[48:49], v17 offset:16384
    ds_read_b64_tr_b16 v[50:51], v17 offset:16896
    v_mfma_f32_32x32x16_bf16 v[120:135], v[64:67], v[56:59], v[120:135]
    v_mfma_f32_32x32x16_bf16 v[136:151], v[52:55], v[68:71], v[136:151]
    v_mfma_f32_32x32x16_bf16 v[152:167], v[56:59], v[68:71], v[152:167]
    s_waitcnt lgkmcnt(5)
    v_mfma_f32_32x32x16_bf16 v[72:87], v[40:43], v[32:35], v[72:87]
    ds_read_b64_tr_b16 v[60:61], v17 offset:2048
    ds_read_b64_tr_b16 v[62:63], v17 offset:2560
    s_waitcnt lgkmcnt(6)
    v_mfma_f32_32x32x16_bf16 v[88:103], v[40:43], v[36:39], v[88:103]
    ds_read_b128 v[52:55], v9 offset:40960
    ds_read_b128 v[56:59], v9 offset:45056
    s_waitcnt lgkmcnt(6)
    v_mfma_f32_32x32x16_bf16 v[104:119], v[44:47], v[32:35], v[104:119]
    ds_read_b64_tr_b16 v[64:65], v17 offset:10240
    ds_read_b64_tr_b16 v[66:67], v17 offset:10752
    v_mfma_f32_32x32x16_bf16 v[120:135], v[44:47], v[36:39], v[120:135]
    ds_read_b64_tr_b16 v[68:69], v17 offset:18432
    ds_read_b64_tr_b16 v[70:71], v17 offset:18944
    s_waitcnt lgkmcnt(8)
    v_mfma_f32_32x32x16_bf16 v[136:151], v[32:35], v[48:51], v[136:151]
    v_mfma_f32_32x32x16_bf16 v[152:167], v[36:39], v[48:51], v[152:167]
    s_waitcnt lgkmcnt(5)
    v_mfma_f32_32x32x16_bf16 v[72:87], v[60:63], v[52:55], v[72:87]
    ds_read_b64_tr_b16 v[40:41], v17 offset:4096
    ds_read_b64_tr_b16 v[42:43], v17 offset:4608
    s_waitcnt lgkmcnt(6)
    v_mfma_f32_32x32x16_bf16 v[88:103], v[60:63], v[56:59], v[88:103]
    ds_read_b128 v[32:35], v10 offset:40960
    ds_read_b128 v[36:39], v10 offset:45056
    s_waitcnt lgkmcnt(6)
    v_mfma_f32_32x32x16_bf16 v[104:119], v[64:67], v[52:55], v[104:119]
    ds_read_b64_tr_b16 v[44:45], v17 offset:12288
    ds_read_b64_tr_b16 v[46:47], v17 offset:12800
    v_mfma_f32_32x32x16_bf16 v[120:135], v[64:67], v[56:59], v[120:135]
    ds_read_b64_tr_b16 v[48:49], v17 offset:20480
    ds_read_b64_tr_b16 v[50:51], v17 offset:20992
    s_waitcnt lgkmcnt(8)
    v_mfma_f32_32x32x16_bf16 v[136:151], v[52:55], v[68:71], v[136:151]
    v_mfma_f32_32x32x16_bf16 v[152:167], v[56:59], v[68:71], v[152:167]
    s_waitcnt lgkmcnt(5)
    v_mfma_f32_32x32x16_bf16 v[72:87], v[40:43], v[32:35], v[72:87]
    ds_read_b64_tr_b16 v[60:61], v17 offset:6144
    ds_read_b64_tr_b16 v[62:63], v17 offset:6656
    s_waitcnt lgkmcnt(6)
    v_mfma_f32_32x32x16_bf16 v[88:103], v[40:43], v[36:39], v[88:103]
    ds_read_b128 v[52:55], v11 offset:40960
    ds_read_b128 v[56:59], v11 offset:45056
    s_waitcnt lgkmcnt(6)
    v_mfma_f32_32x32x16_bf16 v[104:119], v[44:47], v[32:35], v[104:119]
    ds_read_b64_tr_b16 v[64:65], v17 offset:14336
    ds_read_b64_tr_b16 v[66:67], v17 offset:14848
    v_mfma_f32_32x32x16_bf16 v[120:135], v[44:47], v[36:39], v[120:135]
    ds_read_b64_tr_b16 v[68:69], v17 offset:22528
    ds_read_b64_tr_b16 v[70:71], v17 offset:23040
    s_waitcnt lgkmcnt(8)
    v_mfma_f32_32x32x16_bf16 v[136:151], v[32:35], v[48:51], v[136:151]
    v_mfma_f32_32x32x16_bf16 v[152:167], v[36:39], v[48:51], v[152:167]
    s_waitcnt lgkmcnt(0)
    v_mfma_f32_32x32x16_bf16 v[72:87], v[60:63], v[52:55], v[72:87]
    v_mfma_f32_32x32x16_bf16 v[88:103], v[60:63], v[56:59], v[88:103]
    s_barrier
    ds_read_b64_tr_b16 v[40:41], v18 offset:0
    ds_read_b64_tr_b16 v[42:43], v18 offset:512
    ds_read_b128 v[32:35], v12 offset:0
    ds_read_b128 v[36:39], v12 offset:4096
    v_mfma_f32_32x32x16_bf16 v[104:119], v[64:67], v[52:55], v[104:119]
    ds_read_b64_tr_b16 v[44:45], v18 offset:8192
    ds_read_b64_tr_b16 v[46:47], v18 offset:8704
    ds_read_b64_tr_b16 v[48:49], v18 offset:16384
    ds_read_b64_tr_b16 v[50:51], v18 offset:16896
    v_mfma_f32_32x32x16_bf16 v[120:135], v[64:67], v[56:59], v[120:135]
    v_mfma_f32_32x32x16_bf16 v[136:151], v[52:55], v[68:71], v[136:151]
    v_mfma_f32_32x32x16_bf16 v[152:167], v[56:59], v[68:71], v[152:167]
    s_waitcnt lgkmcnt(5)
    v_mfma_f32_32x32x16_bf16 v[72:87], v[40:43], v[32:35], v[72:87]
    ds_read_b64_tr_b16 v[60:61], v18 offset:2048
    ds_read_b64_tr_b16 v[62:63], v18 offset:2560
    s_waitcnt lgkmcnt(6)
    v_mfma_f32_32x32x16_bf16 v[88:103], v[40:43], v[36:39], v[88:103]
    ds_read_b128 v[52:55], v13 offset:0
    ds_read_b128 v[56:59], v13 offset:4096
    s_waitcnt lgkmcnt(6)
    v_mfma_f32_32x32x16_bf16 v[104:119], v[44:47], v[32:35], v[104:119]
    ds_read_b64_tr_b16 v[64:65], v18 offset:10240
    ds_read_b64_tr_b16 v[66:67], v18 offset:10752
    v_mfma_f32_32x32x16_bf16 v[120:135], v[44:47], v[36:39], v[120:135]
    ds_read_b64_tr_b16 v[68:69], v18 offset:18432
    ds_read_b64_tr_b16 v[70:71], v18 offset:18944
    s_waitcnt lgkmcnt(8)
    v_mfma_f32_32x32x16_bf16 v[136:151], v[32:35], v[48:51], v[136:151]
    v_mfma_f32_32x32x16_bf16 v[152:167], v[36:39], v[48:51], v[152:167]
    s_waitcnt lgkmcnt(5)
    v_mfma_f32_32x32x16_bf16 v[72:87], v[60:63], v[52:55], v[72:87]
    ds_read_b64_tr_b16 v[40:41], v18 offset:4096
    ds_read_b64_tr_b16 v[42:43], v18 offset:4608
    s_waitcnt lgkmcnt(6)
    v_mfma_f32_32x32x16_bf16 v[88:103], v[60:63], v[56:59], v[88:103]
    ds_read_b128 v[32:35], v14 offset:0
    ds_read_b128 v[36:39], v14 offset:4096
    s_waitcnt lgkmcnt(6)
    v_mfma_f32_32x32x16_bf16 v[104:119], v[64:67], v[52:55], v[104:119]
    ds_read_b64_tr_b16 v[44:45], v18 offset:12288
    ds_read_b64_tr_b16 v[46:47], v18 offset:12800
    v_mfma_f32_32x32x16_bf16 v[120:135], v[64:67], v[56:59], v[120:135]
    ds_read_b64_tr_b16 v[48:49], v18 offset:20480
    ds_read_b64_tr_b16 v[50:51], v18 offset:20992
    s_waitcnt lgkmcnt(8)
    v_mfma_f32_32x32x16_bf16 v[136:151], v[52:55], v[68:71], v[136:151]
    v_mfma_f32_32x32x16_bf16 v[152:167], v[56:59], v[68:71], v[152:167]
    s_waitcnt lgkmcnt(5)
    v_mfma_f32_32x32x16_bf16 v[72:87], v[40:43], v[32:35], v[72:87]
    ds_read_b64_tr_b16 v[60:61], v18 offset:6144
    ds_read_b64_tr_b16 v[62:63], v18 offset:6656
    s_waitcnt lgkmcnt(6)
    v_mfma_f32_32x32x16_bf16 v[88:103], v[40:43], v[36:39], v[88:103]
    ds_read_b128 v[52:55], v15 offset:0
    ds_read_b128 v[56:59], v15 offset:4096
    s_waitcnt lgkmcnt(6)
    v_mfma_f32_32x32x16_bf16 v[104:119], v[44:47], v[32:35], v[104:119]
    ds_read_b64_tr_b16 v[64:65], v18 offset:14336
    ds_read_b64_tr_b16 v[66:67], v18 offset:14848
    v_mfma_f32_32x32x16_bf16 v[120:135], v[44:47], v[36:39], v[120:135]
    ds_read_b64_tr_b16 v[68:69], v18 offset:22528
    ds_read_b64_tr_b16 v[70:71], v18 offset:23040
    s_waitcnt lgkmcnt(8)
    v_mfma_f32_32x32x16_bf16 v[136:151], v[32:35], v[48:51], v[136:151]
    v_mfma_f32_32x32x16_bf16 v[152:167], v[36:39], v[48:51], v[152:167]
    s_waitcnt lgkmcnt(0)
    v_mfma_f32_32x32x16_bf16 v[72:87], v[60:63], v[52:55], v[72:87]
    v_mfma_f32_32x32x16_bf16 v[88:103], v[60:63], v[56:59], v[88:103]
    s_barrier
    ds_read_b64_tr_b16 v[40:41], v19 offset:0
    ds_read_b64_tr_b16 v[42:43], v19 offset:512
    ds_read_b128 v[32:35], v12 offset:40960
    ds_read_b128 v[36:39], v12 offset:45056
    v_mfma_f32_32x32x16_bf16 v[104:119], v[64:67], v[52:55], v[104:119]
    ds_read_b64_tr_b16 v[44:45], v19 offset:8192
    ds_read_b64_tr_b16 v[46:47], v19 offset:8704
    ds_read_b64_tr_b16 v[48:49], v19 offset:16384
    ds_read_b64_tr_b16 v[50:51], v19 offset:16896
    v_mfma_f32_32x32x16_bf16 v[120:135], v[64:67], v[56:59], v[120:135]
    v_mfma_f32_32x32x16_bf16 v[136:151], v[52:55], v[68:71], v[136:151]
    v_mfma_f32_32x32x16_bf16 v[152:167], v[56:59], v[68:71], v[152:167]
    s_waitcnt lgkmcnt(5)
    v_mfma_f32_32x32x16_bf16 v[72:87], v[40:43], v[32:35], v[72:87]
    ds_read_b64_tr_b16 v[60:61], v19 offset:2048
    ds_read_b64_tr_b16 v[62:63], v19 offset:2560
    s_waitcnt lgkmcnt(6)
    v_mfma_f32_32x32x16_bf16 v[88:103], v[40:43], v[36:39], v[88:103]
    ds_read_b128 v[52:55], v13 offset:40960
    ds_read_b128 v[56:59], v13 offset:45056
    s_waitcnt lgkmcnt(6)
    v_mfma_f32_32x32x16_bf16 v[104:119], v[44:47], v[32:35], v[104:119]
    ds_read_b64_tr_b16 v[64:65], v19 offset:10240
    ds_read_b64_tr_b16 v[66:67], v19 offset:10752
    v_mfma_f32_32x32x16_bf16 v[120:135], v[44:47], v[36:39], v[120:135]
    ds_read_b64_tr_b16 v[68:69], v19 offset:18432
    ds_read_b64_tr_b16 v[70:71], v19 offset:18944
    s_waitcnt lgkmcnt(8)
    v_mfma_f32_32x32x16_bf16 v[136:151], v[32:35], v[48:51], v[136:151]
    v_mfma_f32_32x32x16_bf16 v[152:167], v[36:39], v[48:51], v[152:167]
    s_waitcnt lgkmcnt(5)
    v_mfma_f32_32x32x16_bf16 v[72:87], v[60:63], v[52:55], v[72:87]
    ds_read_b64_tr_b16 v[40:41], v19 offset:4096
    ds_read_b64_tr_b16 v[42:43], v19 offset:4608
    s_waitcnt lgkmcnt(6)
    v_mfma_f32_32x32x16_bf16 v[88:103], v[60:63], v[56:59], v[88:103]
    ds_read_b128 v[32:35], v14 offset:40960
    ds_read_b128 v[36:39], v14 offset:45056
    s_waitcnt lgkmcnt(6)
    v_mfma_f32_32x32x16_bf16 v[104:119], v[64:67], v[52:55], v[104:119]
    ds_read_b64_tr_b16 v[44:45], v19 offset:12288
    ds_read_b64_tr_b16 v[46:47], v19 offset:12800
    v_mfma_f32_32x32x16_bf16 v[120:135], v[64:67], v[56:59], v[120:135]
    ds_read_b64_tr_b16 v[48:49], v19 offset:20480
    ds_read_b64_tr_b16 v[50:51], v19 offset:20992
    s_waitcnt lgkmcnt(8)
    v_mfma_f32_32x32x16_bf16 v[136:151], v[52:55], v[68:71], v[136:151]
    v_mfma_f32_32x32x16_bf16 v[152:167], v[56:59], v[68:71], v[152:167]
    s_waitcnt lgkmcnt(5)
    v_mfma_f32_32x32x16_bf16 v[72:87], v[40:43], v[32:35], v[72:87]
    ds_read_b64_tr_b16 v[60:61], v19 offset:6144
    ds_read_b64_tr_b16 v[62:63], v19 offset:6656
    s_waitcnt lgkmcnt(6)
    v_mfma_f32_32x32x16_bf16 v[88:103], v[40:43], v[36:39], v[88:103]
    ds_read_b128 v[52:55], v15 offset:40960
    ds_read_b128 v[56:59], v15 offset:45056
    s_waitcnt lgkmcnt(6)
    v_mfma_f32_32x32x16_bf16 v[104:119], v[44:47], v[32:35], v[104:119]
    ds_read_b64_tr_b16 v[64:65], v19 offset:14336
    ds_read_b64_tr_b16 v[66:67], v19 offset:14848
    v_mfma_f32_32x32x16_bf16 v[120:135], v[44:47], v[36:39], v[120:135]
    ds_read_b64_tr_b16 v[68:69], v19 offset:22528
    ds_read_b64_tr_b16 v[70:71], v19 offset:23040
    s_waitcnt lgkmcnt(8)
    v_mfma_f32_32x32x16_bf16 v[136:151], v[32:35], v[48:51], v[136:151]
    v_mfma_f32_32x32x16_bf16 v[152:167], v[36:39], v[48:51], v[152:167]
    s_waitcnt lgkmcnt(0)
    v_mfma_f32_32x32x16_bf16 v[72:87], v[60:63], v[52:55], v[72:87]
    v_mfma_f32_32x32x16_bf16 v[88:103], v[60:63], v[56:59], v[88:103]
    v_mfma_f32_32x32x16_bf16 v[104:119], v[64:67], v[52:55], v[104:119]
    v_mfma_f32_32x32x16_bf16 v[120:135], v[64:67], v[56:59], v[120:135]
    v_mfma_f32_32x32x16_bf16 v[136:151], v[52:55], v[68:71], v[136:151]
    v_mfma_f32_32x32x16_bf16 v[152:167], v[56:59], v[68:71], v[152:167]
    s_cmp_eq_u32 s32, 1
    s_cbranch_scc1 concat_heads__sliding_local_dilated__mha_block__prompt_kernel_aepi
    s_nop 6
    v_cvt_pk_bf16_f32 v184, v104, v105
    v_cvt_pk_bf16_f32 v185, v106, v107
    v_cvt_pk_bf16_f32 v186, v108, v109
    v_cvt_pk_bf16_f32 v187, v110, v111
    v_cvt_pk_bf16_f32 v188, v112, v113
    v_cvt_pk_bf16_f32 v189, v114, v115
    v_cvt_pk_bf16_f32 v190, v116, v117
    v_cvt_pk_bf16_f32 v191, v118, v119
    s_add_u32 s37, s8, 2097152
    s_add_u32 s38, s37, 65536
    buffer_store_dwordx4 v[184:187], v249, s[20:23], s37 offen sc1
    buffer_store_dwordx4 v[188:191], v249, s[20:23], s38 offen sc1
    v_cvt_pk_bf16_f32 v192, v120, v121
    v_cvt_pk_bf16_f32 v193, v122, v123
    v_cvt_pk_bf16_f32 v194, v124, v125
    v_cvt_pk_bf16_f32 v195, v126, v127
    v_cvt_pk_bf16_f32 v196, v128, v129
    v_cvt_pk_bf16_f32 v197, v130, v131
    v_cvt_pk_bf16_f32 v198, v132, v133
    v_cvt_pk_bf16_f32 v199, v134, v135
    s_add_u32 s37, s8, 2097152
    s_add_u32 s37, s37, s9
    s_add_u32 s38, s37, 65536
    buffer_store_dwordx4 v[192:195], v249, s[20:23], s37 offen sc1
    buffer_store_dwordx4 v[196:199], v249, s[20:23], s38 offen sc1
    v_cvt_pk_bf16_f32 v200, v136, v137
    v_cvt_pk_bf16_f32 v201, v138, v139
    v_cvt_pk_bf16_f32 v202, v140, v141
    v_cvt_pk_bf16_f32 v203, v142, v143
    v_cvt_pk_bf16_f32 v204, v144, v145
    v_cvt_pk_bf16_f32 v205, v146, v147
    v_cvt_pk_bf16_f32 v206, v148, v149
    v_cvt_pk_bf16_f32 v207, v150, v151
    s_add_u32 s37, s8, 4194304
    buffer_store_dwordx4 v[200:203], v250, s[20:23], s37 offen sc1
    buffer_store_dwordx4 v[204:207], v250, s[20:23], s37 offen offset:512 sc1
    v_cvt_pk_bf16_f32 v208, v152, v153
    v_cvt_pk_bf16_f32 v209, v154, v155
    v_cvt_pk_bf16_f32 v210, v156, v157
    v_cvt_pk_bf16_f32 v211, v158, v159
    v_cvt_pk_bf16_f32 v212, v160, v161
    v_cvt_pk_bf16_f32 v213, v162, v163
    v_cvt_pk_bf16_f32 v214, v164, v165
    v_cvt_pk_bf16_f32 v215, v166, v167
    s_add_u32 s37, s8, 4194304
    s_add_u32 s37, s37, s9
    buffer_store_dwordx4 v[208:211], v250, s[20:23], s37 offen sc1
    buffer_store_dwordx4 v[212:215], v250, s[20:23], s37 offen offset:512 sc1
    v_pk_mul_f32 v[72:73], v[72:73], s[48:49]
    v_pk_mul_f32 v[74:75], v[74:75], s[48:49]
    v_pk_mul_f32 v[76:77], v[76:77], s[48:49]
    v_pk_mul_f32 v[78:79], v[78:79], s[48:49]
    v_pk_mul_f32 v[80:81], v[80:81], s[48:49]
    v_pk_mul_f32 v[82:83], v[82:83], s[48:49]
    v_pk_mul_f32 v[84:85], v[84:85], s[48:49]
    v_pk_mul_f32 v[86:87], v[86:87], s[48:49]
    v_cvt_pk_bf16_f32 v168, v72, v73
    v_cvt_pk_bf16_f32 v169, v74, v75
    v_cvt_pk_bf16_f32 v170, v76, v77
    v_cvt_pk_bf16_f32 v171, v78, v79
    v_cvt_pk_bf16_f32 v172, v80, v81
    v_cvt_pk_bf16_f32 v173, v82, v83
    v_cvt_pk_bf16_f32 v174, v84, v85
    v_cvt_pk_bf16_f32 v175, v86, v87
    s_add_u32 s37, s8, 0
    s_add_u32 s38, s37, 65536
    buffer_store_dwordx4 v[168:171], v248, s[20:23], s37 offen sc1
    buffer_store_dwordx4 v[172:175], v248, s[20:23], s38 offen sc1
    v_pk_mul_f32 v[88:89], v[88:89], s[48:49]
    v_pk_mul_f32 v[90:91], v[90:91], s[48:49]
    v_pk_mul_f32 v[92:93], v[92:93], s[48:49]
    v_pk_mul_f32 v[94:95], v[94:95], s[48:49]
    v_pk_mul_f32 v[96:97], v[96:97], s[48:49]
    v_pk_mul_f32 v[98:99], v[98:99], s[48:49]
    v_pk_mul_f32 v[100:101], v[100:101], s[48:49]
    v_pk_mul_f32 v[102:103], v[102:103], s[48:49]
    v_cvt_pk_bf16_f32 v176, v88, v89
    v_cvt_pk_bf16_f32 v177, v90, v91
    v_cvt_pk_bf16_f32 v178, v92, v93
    v_cvt_pk_bf16_f32 v179, v94, v95
    v_cvt_pk_bf16_f32 v180, v96, v97
    v_cvt_pk_bf16_f32 v181, v98, v99
    v_cvt_pk_bf16_f32 v182, v100, v101
    v_cvt_pk_bf16_f32 v183, v102, v103
    s_add_u32 s37, s8, 0
    s_add_u32 s37, s37, s9
    s_add_u32 s38, s37, 65536
    buffer_store_dwordx4 v[176:179], v248, s[20:23], s37 offen sc1
    buffer_store_dwordx4 v[180:183], v248, s[20:23], s38 offen sc1
    s_branch concat_heads__sliding_local_dilated__mha_block__prompt_kernel_epid
concat_heads__sliding_local_dilated__mha_block__prompt_kernel_aepi:
    s_nop 7
    v_pk_mul_f32 v[72:73], v[72:73], s[48:49]
    v_pk_mul_f32 v[74:75], v[74:75], s[48:49]
    v_pk_mul_f32 v[76:77], v[76:77], s[48:49]
    v_pk_mul_f32 v[78:79], v[78:79], s[48:49]
    v_pk_mul_f32 v[80:81], v[80:81], s[48:49]
    v_pk_mul_f32 v[82:83], v[82:83], s[48:49]
    v_pk_mul_f32 v[84:85], v[84:85], s[48:49]
    v_pk_mul_f32 v[86:87], v[86:87], s[48:49]
    v_cvt_pk_bf16_f32 v168, v72, v73
    v_cvt_pk_bf16_f32 v169, v74, v75
    v_cvt_pk_bf16_f32 v170, v76, v77
    v_cvt_pk_bf16_f32 v171, v78, v79
    v_cvt_pk_bf16_f32 v172, v80, v81
    v_cvt_pk_bf16_f32 v173, v82, v83
    v_cvt_pk_bf16_f32 v174, v84, v85
    v_cvt_pk_bf16_f32 v175, v86, v87
    v_pk_mul_f32 v[88:89], v[88:89], s[48:49]
    v_pk_mul_f32 v[90:91], v[90:91], s[48:49]
    v_pk_mul_f32 v[92:93], v[92:93], s[48:49]
    v_pk_mul_f32 v[94:95], v[94:95], s[48:49]
    v_pk_mul_f32 v[96:97], v[96:97], s[48:49]
    v_pk_mul_f32 v[98:99], v[98:99], s[48:49]
    v_pk_mul_f32 v[100:101], v[100:101], s[48:49]
    v_pk_mul_f32 v[102:103], v[102:103], s[48:49]
    v_cvt_pk_bf16_f32 v176, v88, v89
    v_cvt_pk_bf16_f32 v177, v90, v91
    v_cvt_pk_bf16_f32 v178, v92, v93
    v_cvt_pk_bf16_f32 v179, v94, v95
    v_cvt_pk_bf16_f32 v180, v96, v97
    v_cvt_pk_bf16_f32 v181, v98, v99
    v_cvt_pk_bf16_f32 v182, v100, v101
    v_cvt_pk_bf16_f32 v183, v102, v103
    v_cvt_pk_bf16_f32 v184, v104, v105
    v_cvt_pk_bf16_f32 v185, v106, v107
    v_cvt_pk_bf16_f32 v186, v108, v109
    v_cvt_pk_bf16_f32 v187, v110, v111
    v_cvt_pk_bf16_f32 v188, v112, v113
    v_cvt_pk_bf16_f32 v189, v114, v115
    v_cvt_pk_bf16_f32 v190, v116, v117
    v_cvt_pk_bf16_f32 v191, v118, v119
    v_cvt_pk_bf16_f32 v192, v120, v121
    v_cvt_pk_bf16_f32 v193, v122, v123
    v_cvt_pk_bf16_f32 v194, v124, v125
    v_cvt_pk_bf16_f32 v195, v126, v127
    v_cvt_pk_bf16_f32 v196, v128, v129
    v_cvt_pk_bf16_f32 v197, v130, v131
    v_cvt_pk_bf16_f32 v198, v132, v133
    v_cvt_pk_bf16_f32 v199, v134, v135
    v_cvt_pk_bf16_f32 v200, v136, v137
    v_cvt_pk_bf16_f32 v201, v138, v139
    v_cvt_pk_bf16_f32 v202, v140, v141
    v_cvt_pk_bf16_f32 v203, v142, v143
    v_cvt_pk_bf16_f32 v204, v144, v145
    v_cvt_pk_bf16_f32 v205, v146, v147
    v_cvt_pk_bf16_f32 v206, v148, v149
    v_cvt_pk_bf16_f32 v207, v150, v151
    v_cvt_pk_bf16_f32 v208, v152, v153
    v_cvt_pk_bf16_f32 v209, v154, v155
    v_cvt_pk_bf16_f32 v210, v156, v157
    v_cvt_pk_bf16_f32 v211, v158, v159
    v_cvt_pk_bf16_f32 v212, v160, v161
    v_cvt_pk_bf16_f32 v213, v162, v163
    v_cvt_pk_bf16_f32 v214, v164, v165
    v_cvt_pk_bf16_f32 v215, v166, v167
concat_heads__sliding_local_dilated__mha_block__prompt_kernel_epid:
concat_heads__sliding_local_dilated__mha_block__prompt_kernel_join:
    s_mov_b32 s10, s28
    s_cmp_lt_u32 s33, 4
    s_cselect_b32 s11, s32, 0
    s_lshl_b32 s28, s26, 2
    s_lshr_b32 s34, s27, 3
    s_add_u32 s28, s28, s34
    s_and_b32 s30, s27, 7
    s_lshl_b32 s29, s30, 3
    s_add_u32 s29, s29, s33
    s_lshl_b32 s34, s28, 16
    s_lshl_b32 s43, s29, 10
    s_add_u32 s43, s43, s34
    s_add_u32 s43, s43, 8388608
    s_and_b32 s35, s33, 1
    s_lshl_b32 s35, s35, 5
    s_lshl_b32 s36, s30, 2
    s_add_u32 s35, s35, s36
    s_lshr_b32 s36, s33, 1
    s_add_u32 s29, s35, s36
    s_lshl_b32 s35, s29, 10
    s_add_u32 s35, s35, s34
    s_and_b32 s36, s29, 31
    s_cmp_eq_u32 s36, 0
    s_cselect_b32 s36, 0, 1024
    s_cselect_b32 s37, 99, 25
    s_sub_u32 s36, s35, s36
    v_lshlrev_b32 v2, 4, v1
    s_lshl_b32 s38, s33, 10
    v_add_u32 v3, s38, v2
    v_lshrrev_b32 v137, 5, v1
    v_and_b32 v138, 15, v1
    v_lshlrev_b32 v139, 7, v138
    v_lshlrev_b32 v138, 4, v138
    s_lshl_b32 s39, s26, 11
    s_add_u32 s39, s39, 16777216
    v_add_u32 v155, s39, v139
    v_lshlrev_b32 v139, 8, v137
    v_add_u32 v153, v138, v139
    s_add_u32 s46, s34, 10485760
    s_add_u32 s47, s34, 12582912
    s_mul_i32 s48, s33, 1024
    s_add_u32 s48, s48, 65536
    v_mov_b32 v124, 0x3f803f80
    v_mov_b32 v125, 0x3f803f80
    v_mov_b32 v126, 0x3f803f80
    v_mov_b32 v127, 0x3f803f80
    v_mov_b32 v128, 0x3f803f80
    v_mov_b32 v129, 0x3f803f80
    v_mov_b32 v130, 0x3f803f80
    v_mov_b32 v131, 0x3f803f80
    v_mov_b32 v132, 0x3f803f80
    v_mov_b32 v133, 0x3f803f80
    v_mov_b32 v134, 0x3f803f80
    v_mov_b32 v135, 0x3f803f80
    v_mov_b32 v108, 0xdddddddd
    v_mov_b32 v152, 0xf149f2ca
    v_mov_b32 v109, v2
    v_and_b32 v141, 16, v1
    v_cmp_eq_u32 vcc, 0, v141
    v_add_u32 v142, 65536, v153
    v_add_u32 v143, 512, v142
    v_mov_b32 v148, 66560
    v_and_b32 v150, 27, v1
    v_cmp_eq_u32_e64 s[50:51], 16, v150
    v_mov_b32 v150, 0x3f803f80
    s_mov_b32 s44, 0x0000ffff
    s_mov_b32 s45, 0x0000ffff
    v_cndmask_b32_e64 v92, 0, v150, s[50:51]
    v_mov_b32 v93, v92
    v_mov_b32 v94, v92
    v_mov_b32 v95, v92
    v_mov_b32 v96, v92
    v_mov_b32 v97, v92
    v_mov_b32 v98, v92
    v_mov_b32 v99, v92
    v_mov_b32 v100, v92
    v_mov_b32 v101, v92
    v_mov_b32 v102, v92
    v_mov_b32 v103, v92
    v_mov_b32 v104, v92
    v_mov_b32 v105, v92
    v_mov_b32 v106, v92
    v_mov_b32 v107, v92
    v_mov_b32 v148, v142
    s_mov_b64 vcc, -1
    v_cndmask_b32 v110, v148, v142, vcc
    v_cndmask_b32 v111, v148, v143, vcc
    v_and_b32 v141, 31, v1
    v_lshlrev_b32 v142, 3, v137
    v_sub_u32 v149, v141, v142
    v_subrev_u32 v136, 0, v149
    v_cmp_gt_u32_e64 s[50:51], 8, v136
    v_subrev_u32 v137, 1, v149
    v_cmp_gt_u32_e64 s[52:53], 8, v137
    v_subrev_u32 v138, 2, v149
    v_cmp_gt_u32_e64 s[54:55], 8, v138
    v_subrev_u32 v139, 3, v149
    v_cmp_gt_u32_e64 s[56:57], 8, v139
    v_cndmask_b32_e64 v216, v152, 0, s[50:51]
    v_cndmask_b32_e64 v217, v152, 0, s[52:53]
    v_cndmask_b32_e64 v218, v152, 0, s[54:55]
    v_cndmask_b32_e64 v219, v152, 0, s[56:57]
    v_subrev_u32 v136, 4, v149
    v_cmp_gt_u32_e64 s[50:51], 8, v136
    v_subrev_u32 v137, 5, v149
    v_cmp_gt_u32_e64 s[52:53], 8, v137
    v_subrev_u32 v138, 6, v149
    v_cmp_gt_u32_e64 s[54:55], 8, v138
    v_subrev_u32 v139, 7, v149
    v_cmp_gt_u32_e64 s[56:57], 8, v139
    v_cndmask_b32_e64 v220, v152, 0, s[50:51]
    v_cndmask_b32_e64 v221, v152, 0, s[52:53]
    v_cndmask_b32_e64 v222, v152, 0, s[54:55]
    v_cndmask_b32_e64 v223, v152, 0, s[56:57]
    v_subrev_u32 v136, 16, v149
    v_cmp_gt_u32_e64 s[50:51], 8, v136
    v_subrev_u32 v137, 17, v149
    v_cmp_gt_u32_e64 s[52:53], 8, v137
    v_subrev_u32 v138, 18, v149
    v_cmp_gt_u32_e64 s[54:55], 8, v138
    v_subrev_u32 v139, 19, v149
    v_cmp_gt_u32_e64 s[56:57], 8, v139
    v_cndmask_b32_e64 v224, v152, 0, s[50:51]
    v_cndmask_b32_e64 v225, v152, 0, s[52:53]
    v_cndmask_b32_e64 v226, v152, 0, s[54:55]
    v_cndmask_b32_e64 v227, v152, 0, s[56:57]
    v_subrev_u32 v136, 20, v149
    v_cmp_gt_u32_e64 s[50:51], 8, v136
    v_subrev_u32 v137, 21, v149
    v_cmp_gt_u32_e64 s[52:53], 8, v137
    v_subrev_u32 v138, 22, v149
    v_cmp_gt_u32_e64 s[54:55], 8, v138
    v_subrev_u32 v139, 23, v149
    v_cmp_gt_u32_e64 s[56:57], 8, v139
    v_cndmask_b32_e64 v228, v152, 0, s[50:51]
    v_cndmask_b32_e64 v229, v152, 0, s[52:53]
    v_cndmask_b32_e64 v230, v152, 0, s[54:55]
    v_cndmask_b32_e64 v231, v152, 0, s[56:57]
    v_sub_u32 v136, 16, v149
    v_cmp_le_i32_e64 s[50:51], s37, v136
    v_sub_u32 v137, 17, v149
    v_cmp_le_i32_e64 s[52:53], s37, v137
    v_sub_u32 v138, 18, v149
    v_cmp_le_i32_e64 s[54:55], s37, v138
    v_sub_u32 v139, 19, v149
    v_cmp_le_i32_e64 s[56:57], s37, v139
    v_cndmask_b32_e64 v240, v152, 0, s[50:51]
    v_cndmask_b32_e64 v241, v152, 0, s[52:53]
    v_cndmask_b32_e64 v242, v152, 0, s[54:55]
    v_cndmask_b32_e64 v243, v152, 0, s[56:57]
    v_sub_u32 v136, 20, v149
    v_cmp_le_i32_e64 s[50:51], s37, v136
    v_sub_u32 v137, 21, v149
    v_cmp_le_i32_e64 s[52:53], s37, v137
    v_sub_u32 v138, 22, v149
    v_cmp_le_i32_e64 s[54:55], s37, v138
    v_sub_u32 v139, 23, v149
    v_cmp_le_i32_e64 s[56:57], s37, v139
    v_cndmask_b32_e64 v244, v152, 0, s[50:51]
    v_cndmask_b32_e64 v245, v152, 0, s[52:53]
    v_cndmask_b32_e64 v246, v152, 0, s[54:55]
    v_cndmask_b32_e64 v247, v152, 0, s[56:57]
    v_mov_b32 v232, 0
    v_mov_b32 v233, 0
    v_mov_b32 v234, 0
    v_mov_b32 v235, 0
    v_mov_b32 v236, 0
    v_mov_b32 v237, 0
    v_mov_b32 v238, 0
    v_mov_b32 v239, 0
    v_mov_b32 v16, 0
    v_mov_b32 v17, 0
    v_mov_b32 v18, 0
    v_mov_b32 v19, 0
    v_mov_b32 v20, 0
    v_mov_b32 v21, 0
    v_mov_b32 v22, 0
    v_mov_b32 v23, 0
    v_mov_b32 v24, 0
    v_mov_b32 v25, 0
    v_mov_b32 v26, 0
    v_mov_b32 v27, 0
    v_mov_b32 v28, 0
    v_mov_b32 v29, 0
    v_mov_b32 v30, 0
    v_mov_b32 v31, 0
    v_mul_u32_u24 v140, 1024, v1
    v_add_u32 v140, 66560, v140
    v_mov_b32 v144, 0x3f803f80
    v_mov_b32 v145, 0x3f803f80
    v_mov_b32 v146, 0x3f803f80
    v_mov_b32 v147, 0x3f803f80
    s_waitcnt vmcnt(0)
    s_barrier
    s_cmp_eq_u32 s33, 7
    s_cbranch_scc0 concat_heads__sliding_local_dilated__mha_block__prompt_kernel_y
    s_cmp_eq_u32 s32, 1
    s_cbranch_scc1 concat_heads__sliding_local_dilated__mha_block__prompt_kernel_noflagb
    v_mov_b32 v136, s3
    v_mov_b32 v137, s10
    s_mov_b64 exec, 1
    buffer_store_dword v136, v137, s[20:23], 0 offen sc1
    s_mov_b64 exec, -1
concat_heads__sliding_local_dilated__mha_block__prompt_kernel_noflagb:
    s_mov_b32 s51, 0
concat_heads__sliding_local_dilated__mha_block__prompt_kernel_poll2:
    buffer_load_dword v136, v155, s[20:23], 0 offen sc1
concat_heads__sliding_local_dilated__mha_block__prompt_kernel_poll2_chk:
    s_waitcnt vmcnt(0)
    v_cmp_ne_u32 vcc, s3, v136
    s_cbranch_vccz concat_heads__sliding_local_dilated__mha_block__prompt_kernel_poll2_ok
    s_add_u32 s51, s51, 1
    s_cmp_lt_u32 s51, 32768
    s_cbranch_scc1 concat_heads__sliding_local_dilated__mha_block__prompt_kernel_poll2
concat_heads__sliding_local_dilated__mha_block__prompt_kernel_poll2_ok:
concat_heads__sliding_local_dilated__mha_block__prompt_kernel_y:
    s_barrier
    buffer_load_dwordx4 v[4:7], v2, s[20:23], s43 offen sc1
    s_add_u32 s49, s30, 0
    s_and_b32 s49, s49, 7
    s_lshl_b32 s49, s49, 13
    s_add_u32 m0, s38, 0
    s_add_u32 s50, s46, s49
    buffer_load_dwordx4 v3, s[20:23], s50 offen sc1 lds
    s_add_u32 m0, s48, 0
    s_add_u32 s50, s47, s49
    buffer_load_dwordx4 v3, s[20:23], s50 offen sc1 lds
    s_add_u32 s49, s30, 1
    s_and_b32 s49, s49, 7
    s_lshl_b32 s49, s49, 13
    s_add_u32 m0, s38, 8192
    s_add_u32 s50, s46, s49
    buffer_load_dwordx4 v3, s[20:23], s50 offen sc1 lds
    s_add_u32 m0, s48, 8192
    s_add_u32 s50, s47, s49
    buffer_load_dwordx4 v3, s[20:23], s50 offen sc1 lds
    v_min_u32 v136, 2, v1
    s_lshl_b32 s49, s30, 1
    v_add_u32 v136, s49, v136
    v_max_u32 v136, 1, v136
    v_subrev_u32 v136, 1, v136
    v_min_u32 v136, 15, v136
    v_lshlrev_b32 v136, 7, v136
    s_lshl_b32 s49, s26, 11
    s_add_u32 s49, s49, 16793600
    v_add_u32 v155, s49, v136
    s_waitcnt vmcnt(2)
    s_barrier
    ds_read_b128 v[80:83], v109 offset:0
    ds_read_b128 v[84:87], v109 offset:1024
    s_mov_b64 exec, s[44:45]
    ds_read_b128 v[92:95], v110 offset:0
    ds_read_b128 v[96:99], v111 offset:0
    s_mov_b64 exec, -1
    s_waitcnt lgkmcnt(3)
    v_mfma_f32_32x32x16_bf16 v[32:47], v[80:83], v[4:7], 0
    s_add_u32 s49, s30, 2
    s_and_b32 s49, s49, 7
    s_lshl_b32 s49, s49, 13
    s_add_u32 m0, s38, 16384
    s_add_u32 s50, s46, s49
    buffer_load_dwordx4 v3, s[20:23], s50 offen sc1 lds
    s_add_u32 m0, s48, 16384
    s_add_u32 s50, s47, s49
    buffer_load_dwordx4 v3, s[20:23], s50 offen sc1 lds
    s_setprio 2
    s_waitcnt lgkmcnt(0)
    s_nop 0
    v_exp_f32 v32, v32
    v_exp_f32 v33, v33
    ds_read_b128 v[80:83], v109 offset:2048
    s_mov_b64 exec, s[44:45]
    ds_read_b128 v[100:103], v110 offset:1024
    ds_read_b128 v[104:107], v111 offset:1024
    s_mov_b64 exec, -1
    v_exp_f32 v34, v34
    v_exp_f32 v35, v35
    v_exp_f32 v36, v36
    v_exp_f32 v37, v37
    v_exp_f32 v38, v38
    v_mfma_f32_32x32x16_bf16 v[48:63], v[84:87], v[4:7], 0
    v_exp_f32 v39, v39
    v_exp_f32 v40, v40
    v_exp_f32 v41, v41
    v_exp_f32 v42, v42
    v_smfmac_f32_32x32x32_bf16 v[16:31], v[92:95], v[32:39], v108
    v_exp_f32 v43, v43
    v_exp_f32 v44, v44
    v_exp_f32 v45, v45
    v_exp_f32 v46, v46
    v_exp_f32 v47, v47
    s_add_u32 s49, s30, 3
    s_and_b32 s49, s49, 7
    s_lshl_b32 s49, s49, 13
    s_add_u32 m0, s38, 24576
    s_add_u32 s50, s46, s49
    buffer_load_dwordx4 v3, s[20:23], s50 offen sc1 lds
    s_add_u32 m0, s48, 24576
    s_add_u32 s50, s47, s49
    buffer_load_dwordx4 v3, s[20:23], s50 offen sc1 lds
    s_waitcnt lgkmcnt(0)
    v_exp_f32 v48, v48
    v_exp_f32 v49, v49
    v_smfmac_f32_32x32x32_bf16 v[16:31], v[96:99], v[40:47], v108
    ds_read_b128 v[84:87], v109 offset:3072
    s_mov_b64 exec, s[44:45]
    ds_read_b128 v[92:95], v110 offset:2048
    ds_read_b128 v[96:99], v111 offset:2048
    s_mov_b64 exec, -1
    v_exp_f32 v50, v50
    v_exp_f32 v51, v51
    v_exp_f32 v52, v52
    v_exp_f32 v53, v53
    v_exp_f32 v54, v54
    v_mfma_f32_32x32x16_bf16 v[64:79], v[80:83], v[4:7], 0
    v_exp_f32 v55, v55
    v_exp_f32 v56, v56
    v_exp_f32 v57, v57
    v_exp_f32 v58, v58
    v_smfmac_f32_32x32x32_bf16 v[16:31], v[100:103], v[48:55], v108
    v_exp_f32 v59, v59
    v_exp_f32 v60, v60
    v_exp_f32 v61, v61
    v_exp_f32 v62, v62
    v_exp_f32 v63, v63
    s_add_u32 s49, s30, 4
    s_and_b32 s49, s49, 7
    s_lshl_b32 s49, s49, 13
    s_add_u32 m0, s38, 32768
    s_add_u32 s50, s46, s49
    buffer_load_dwordx4 v3, s[20:23], s50 offen sc1 lds
    s_add_u32 m0, s48, 32768
    s_add_u32 s50, s47, s49
    buffer_load_dwordx4 v3, s[20:23], s50 offen sc1 lds
    s_waitcnt lgkmcnt(0)
    v_exp_f32 v64, v64
    v_exp_f32 v65, v65
    v_smfmac_f32_32x32x32_bf16 v[16:31], v[104:107], v[56:63], v108
    ds_read_b128 v[80:83], v109 offset:4096
    s_mov_b64 exec, s[44:45]
    ds_read_b128 v[100:103], v110 offset:3072
    ds_read_b128 v[104:107], v111 offset:3072
    s_mov_b64 exec, -1
    v_exp_f32 v66, v66
    v_exp_f32 v67, v67
    v_exp_f32 v68, v68
    v_exp_f32 v69, v69
    v_exp_f32 v70, v70
    v_mfma_f32_32x32x16_bf16 v[32:47], v[84:87], v[4:7], 0
    v_exp_f32 v71, v71
    v_exp_f32 v72, v72
    v_exp_f32 v73, v73
    v_exp_f32 v74, v74
    v_smfmac_f32_32x32x32_bf16 v[16:31], v[92:95], v[64:71], v108
    v_exp_f32 v75, v75
    v_exp_f32 v76, v76
    v_exp_f32 v77, v77
    v_exp_f32 v78, v78
    v_exp_f32 v79, v79
    s_add_u32 s49, s30, 5
    s_and_b32 s49, s49, 7
    s_lshl_b32 s49, s49, 13
    s_add_u32 m0, s38, 40960
    s_add_u32 s50, s46, s49
    buffer_load_dwordx4 v3, s[20:23], s50 offen sc1 lds
    s_add_u32 m0, s48, 40960
    s_add_u32 s50, s47, s49
    buffer_load_dwordx4 v3, s[20:23], s50 offen sc1 lds
    s_setprio 1
    s_waitcnt lgkmcnt(0)
    v_exp_f32 v32, v32
    v_exp_f32 v33, v33
    v_smfmac_f32_32x32x32_bf16 v[16:31], v[96:99], v[72:79], v108
    ds_read_b128 v[84:87], v109 offset:5120
    s_mov_b64 exec, s[44:45]
    ds_read_b128 v[92:95], v110 offset:4096
    ds_read_b128 v[96:99], v111 offset:4096
    s_mov_b64 exec, -1
    v_exp_f32 v34, v34
    v_exp_f32 v35, v35
    v_exp_f32 v36, v36
    v_exp_f32 v37, v37
    v_exp_f32 v38, v38
    v_mfma_f32_32x32x16_bf16 v[48:63], v[80:83], v[4:7], 0
    v_exp_f32 v39, v39
    v_exp_f32 v40, v40
    v_exp_f32 v41, v41
    v_exp_f32 v42, v42
    v_smfmac_f32_32x32x32_bf16 v[16:31], v[100:103], v[32:39], v108
    v_exp_f32 v43, v43
    v_exp_f32 v44, v44
    v_exp_f32 v45, v45
    v_exp_f32 v46, v46
    v_exp_f32 v47, v47
    s_add_u32 s49, s30, 6
    s_and_b32 s49, s49, 7
    s_lshl_b32 s49, s49, 13
    s_add_u32 m0, s38, 49152
    s_add_u32 s50, s46, s49
    buffer_load_dwordx4 v3, s[20:23], s50 offen sc1 lds
    s_add_u32 m0, s48, 49152
    s_add_u32 s50, s47, s49
    buffer_load_dwordx4 v3, s[20:23], s50 offen sc1 lds
    s_waitcnt lgkmcnt(0)
    v_exp_f32 v48, v48
    v_exp_f32 v49, v49
    v_smfmac_f32_32x32x32_bf16 v[16:31], v[104:107], v[40:47], v108
    ds_read_b128 v[80:83], v109 offset:6144
    s_mov_b64 exec, s[44:45]
    ds_read_b128 v[100:103], v110 offset:5120
    ds_read_b128 v[104:107], v111 offset:5120
    s_mov_b64 exec, -1
    v_exp_f32 v50, v50
    v_exp_f32 v51, v51
    v_exp_f32 v52, v52
    v_exp_f32 v53, v53
    v_exp_f32 v54, v54
    v_mfma_f32_32x32x16_bf16 v[64:79], v[84:87], v[4:7], 0
    v_exp_f32 v55, v55
    v_exp_f32 v56, v56
    v_exp_f32 v57, v57
    v_exp_f32 v58, v58
    v_smfmac_f32_32x32x32_bf16 v[16:31], v[92:95], v[48:55], v108
    v_exp_f32 v59, v59
    v_exp_f32 v60, v60
    v_exp_f32 v61, v61
    v_exp_f32 v62, v62
    v_exp_f32 v63, v63
    s_add_u32 s49, s30, 7
    s_and_b32 s49, s49, 7
    s_lshl_b32 s49, s49, 13
    s_add_u32 m0, s38, 57344
    s_add_u32 s50, s46, s49
    buffer_load_dwordx4 v3, s[20:23], s50 offen sc1 lds
    s_add_u32 m0, s48, 57344
    s_add_u32 s50, s47, s49
    buffer_load_dwordx4 v3, s[20:23], s50 offen sc1 lds
    s_setprio 0
    s_waitcnt lgkmcnt(0)
    v_exp_f32 v64, v64
    v_exp_f32 v65, v65
    v_smfmac_f32_32x32x32_bf16 v[16:31], v[96:99], v[56:63], v108
    ds_read_b128 v[84:87], v109 offset:7168
    s_mov_b64 exec, s[44:45]
    ds_read_b128 v[92:95], v110 offset:6144
    ds_read_b128 v[96:99], v111 offset:6144
    s_mov_b64 exec, -1
    v_exp_f32 v66, v66
    v_exp_f32 v67, v67
    v_exp_f32 v68, v68
    v_exp_f32 v69, v69
    v_exp_f32 v70, v70
    v_mfma_f32_32x32x16_bf16 v[32:47], v[80:83], v[4:7], 0
    v_exp_f32 v71, v71
    v_exp_f32 v72, v72
    v_exp_f32 v73, v73
    v_exp_f32 v74, v74
    v_smfmac_f32_32x32x32_bf16 v[16:31], v[100:103], v[64:71], v108
    v_exp_f32 v75, v75
    v_exp_f32 v76, v76
    v_exp_f32 v77, v77
    v_exp_f32 v78, v78
    v_exp_f32 v79, v79
    s_waitcnt vmcnt(12)
    s_barrier
    s_setprio 3
    s_waitcnt lgkmcnt(0)
    v_exp_f32 v32, v32
    v_exp_f32 v33, v33
    v_smfmac_f32_32x32x32_bf16 v[16:31], v[104:107], v[72:79], v108
    ds_read_b128 v[80:83], v109 offset:8192
    s_mov_b64 exec, s[44:45]
    ds_read_b128 v[100:103], v110 offset:7168
    ds_read_b128 v[104:107], v111 offset:7168
    s_mov_b64 exec, -1
    v_exp_f32 v34, v34
    v_exp_f32 v35, v35
    v_exp_f32 v36, v36
    v_exp_f32 v37, v37
    v_exp_f32 v38, v38
    v_mfma_f32_32x32x16_bf16 v[48:63], v[84:87], v[4:7], 0
    v_exp_f32 v39, v39
    v_exp_f32 v40, v40
    v_exp_f32 v41, v41
    v_exp_f32 v42, v42
    v_smfmac_f32_32x32x32_bf16 v[16:31], v[92:95], v[32:39], v108
    v_exp_f32 v43, v43
    v_exp_f32 v44, v44
    v_exp_f32 v45, v45
    v_exp_f32 v46, v46
    v_exp_f32 v47, v47
    s_setprio 2
    s_waitcnt lgkmcnt(0)
    v_exp_f32 v48, v48
    v_exp_f32 v49, v49
    v_smfmac_f32_32x32x32_bf16 v[16:31], v[96:99], v[40:47], v108
    ds_read_b128 v[84:87], v109 offset:9216
    s_mov_b64 exec, s[44:45]
    ds_read_b128 v[92:95], v110 offset:8192
    ds_read_b128 v[96:99], v111 offset:8192
    s_mov_b64 exec, -1
    v_exp_f32 v50, v50
    v_exp_f32 v51, v51
    v_exp_f32 v52, v52
    v_exp_f32 v53, v53
    v_exp_f32 v54, v54
    v_mfma_f32_32x32x16_bf16 v[64:79], v[80:83], v[4:7], 0
    v_exp_f32 v55, v55
    v_exp_f32 v56, v56
    v_exp_f32 v57, v57
    v_exp_f32 v58, v58
    v_smfmac_f32_32x32x32_bf16 v[16:31], v[100:103], v[48:55], v108
    v_exp_f32 v59, v59
    v_exp_f32 v60, v60
    v_exp_f32 v61, v61
    v_exp_f32 v62, v62
    v_exp_f32 v63, v63
    s_waitcnt lgkmcnt(0)
    s_nop 0
    v_exp_f32 v64, v64
    v_exp_f32 v65, v65
    v_smfmac_f32_32x32x32_bf16 v[16:31], v[104:107], v[56:63], v108
    ds_read_b128 v[80:83], v109 offset:10240
    s_mov_b64 exec, s[44:45]
    ds_read_b128 v[100:103], v110 offset:9216
    ds_read_b128 v[104:107], v111 offset:9216
    s_mov_b64 exec, -1
    v_exp_f32 v66, v66
    v_exp_f32 v67, v67
    v_exp_f32 v68, v68
    v_exp_f32 v69, v69
    v_exp_f32 v70, v70
    v_mfma_f32_32x32x16_bf16 v[32:47], v[84:87], v[4:7], 0
    v_exp_f32 v71, v71
    v_exp_f32 v72, v72
    v_exp_f32 v73, v73
    v_exp_f32 v74, v74
    v_smfmac_f32_32x32x32_bf16 v[16:31], v[92:95], v[64:71], v108
    v_exp_f32 v75, v75
    v_exp_f32 v76, v76
    v_exp_f32 v77, v77
    v_exp_f32 v78, v78
    v_exp_f32 v79, v79
    s_waitcnt lgkmcnt(0)
    s_nop 0
    v_exp_f32 v32, v32
    v_exp_f32 v33, v33
    v_smfmac_f32_32x32x32_bf16 v[16:31], v[96:99], v[72:79], v108
    ds_read_b128 v[84:87], v109 offset:11264
    s_mov_b64 exec, s[44:45]
    ds_read_b128 v[92:95], v110 offset:10240
    ds_read_b128 v[96:99], v111 offset:10240
    s_mov_b64 exec, -1
    v_exp_f32 v34, v34
    v_exp_f32 v35, v35
    v_exp_f32 v36, v36
    v_exp_f32 v37, v37
    v_exp_f32 v38, v38
    v_mfma_f32_32x32x16_bf16 v[48:63], v[80:83], v[4:7], 0
    v_exp_f32 v39, v39
    v_exp_f32 v40, v40
    v_exp_f32 v41, v41
    v_exp_f32 v42, v42
    v_smfmac_f32_32x32x32_bf16 v[16:31], v[100:103], v[32:39], v108
    v_exp_f32 v43, v43
    v_exp_f32 v44, v44
    v_exp_f32 v45, v45
    v_exp_f32 v46, v46
    v_exp_f32 v47, v47
    s_waitcnt lgkmcnt(0)
    s_nop 0
    v_exp_f32 v48, v48
    v_exp_f32 v49, v49
    v_smfmac_f32_32x32x32_bf16 v[16:31], v[104:107], v[40:47], v108
    ds_read_b128 v[80:83], v109 offset:12288
    s_mov_b64 exec, s[44:45]
    ds_read_b128 v[100:103], v110 offset:11264
    ds_read_b128 v[104:107], v111 offset:11264
    s_mov_b64 exec, -1
    v_exp_f32 v50, v50
    v_exp_f32 v51, v51
    v_exp_f32 v52, v52
    v_exp_f32 v53, v53
    v_exp_f32 v54, v54
    v_mfma_f32_32x32x16_bf16 v[64:79], v[84:87], v[4:7], 0
    v_exp_f32 v55, v55
    v_exp_f32 v56, v56
    v_exp_f32 v57, v57
    v_exp_f32 v58, v58
    v_smfmac_f32_32x32x32_bf16 v[16:31], v[92:95], v[48:55], v108
    v_exp_f32 v59, v59
    v_exp_f32 v60, v60
    v_exp_f32 v61, v61
    v_exp_f32 v62, v62
    v_exp_f32 v63, v63
    s_setprio 1
    s_waitcnt lgkmcnt(0)
    v_exp_f32 v64, v64
    v_exp_f32 v65, v65
    v_smfmac_f32_32x32x32_bf16 v[16:31], v[96:99], v[56:63], v108
    ds_read_b128 v[84:87], v109 offset:13312
    s_mov_b64 exec, s[44:45]
    ds_read_b128 v[92:95], v110 offset:12288
    ds_read_b128 v[96:99], v111 offset:12288
    s_mov_b64 exec, -1
    v_exp_f32 v66, v66
    v_exp_f32 v67, v67
    v_exp_f32 v68, v68
    v_exp_f32 v69, v69
    v_exp_f32 v70, v70
    v_mfma_f32_32x32x16_bf16 v[32:47], v[80:83], v[4:7], 0
    v_exp_f32 v71, v71
    v_exp_f32 v72, v72
    v_exp_f32 v73, v73
    v_exp_f32 v74, v74
    v_smfmac_f32_32x32x32_bf16 v[16:31], v[100:103], v[64:71], v108
    v_exp_f32 v75, v75
    v_exp_f32 v76, v76
    v_exp_f32 v77, v77
    v_exp_f32 v78, v78
    v_exp_f32 v79, v79
    s_waitcnt lgkmcnt(0)
    s_nop 0
    v_exp_f32 v32, v32
    v_exp_f32 v33, v33
    v_smfmac_f32_32x32x32_bf16 v[16:31], v[104:107], v[72:79], v108
    ds_read_b128 v[80:83], v109 offset:14336
    s_mov_b64 exec, s[44:45]
    ds_read_b128 v[100:103], v110 offset:13312
    ds_read_b128 v[104:107], v111 offset:13312
    s_mov_b64 exec, -1
    v_exp_f32 v34, v34
    v_exp_f32 v35, v35
    v_exp_f32 v36, v36
    v_exp_f32 v37, v37
    v_exp_f32 v38, v38
    v_mfma_f32_32x32x16_bf16 v[48:63], v[84:87], v[4:7], 0
    v_exp_f32 v39, v39
    v_exp_f32 v40, v40
    v_exp_f32 v41, v41
    v_exp_f32 v42, v42
    v_smfmac_f32_32x32x32_bf16 v[16:31], v[92:95], v[32:39], v108
    v_exp_f32 v43, v43
    v_exp_f32 v44, v44
    v_exp_f32 v45, v45
    v_exp_f32 v46, v46
    v_exp_f32 v47, v47
    s_setprio 0
    s_waitcnt lgkmcnt(0)
    v_exp_f32 v48, v48
    v_exp_f32 v49, v49
    v_smfmac_f32_32x32x32_bf16 v[16:31], v[96:99], v[40:47], v108
    ds_read_b128 v[84:87], v109 offset:15360
    s_mov_b64 exec, s[44:45]
    ds_read_b128 v[92:95], v110 offset:14336
    ds_read_b128 v[96:99], v111 offset:14336
    s_mov_b64 exec, -1
    v_exp_f32 v50, v50
    v_exp_f32 v51, v51
    v_exp_f32 v52, v52
    v_exp_f32 v53, v53
    v_exp_f32 v54, v54
    v_mfma_f32_32x32x16_bf16 v[64:79], v[80:83], v[4:7], 0
    v_exp_f32 v55, v55
    v_exp_f32 v56, v56
    v_exp_f32 v57, v57
    v_exp_f32 v58, v58
    v_smfmac_f32_32x32x32_bf16 v[16:31], v[100:103], v[48:55], v108
    v_exp_f32 v59, v59
    v_exp_f32 v60, v60
    v_exp_f32 v61, v61
    v_exp_f32 v62, v62
    v_exp_f32 v63, v63
    s_waitcnt vmcnt(0)
    s_barrier
    s_cmp_eq_u32 s11, 1
    s_cbranch_scc0 concat_heads__sliding_local_dilated__mha_block__prompt_kernel_nodef
    s_add_u32 s37, s8, 0
    s_add_u32 s38, s37, 65536
    buffer_store_dwordx4 v[168:171], v248, s[20:23], s37 offen sc1
    buffer_store_dwordx4 v[172:175], v248, s[20:23], s38 offen sc1
    s_add_u32 s37, s8, 0
    s_add_u32 s37, s37, s9
    s_add_u32 s38, s37, 65536
    buffer_store_dwordx4 v[176:179], v248, s[20:23], s37 offen sc1
    buffer_store_dwordx4 v[180:183], v248, s[20:23], s38 offen sc1
    s_add_u32 s37, s8, 2097152
    s_add_u32 s38, s37, 65536
    buffer_store_dwordx4 v[184:187], v249, s[20:23], s37 offen sc1
    buffer_store_dwordx4 v[188:191], v249, s[20:23], s38 offen sc1
    s_add_u32 s37, s8, 2097152
    s_add_u32 s37, s37, s9
    s_add_u32 s38, s37, 65536
    buffer_store_dwordx4 v[192:195], v249, s[20:23], s37 offen sc1
    buffer_store_dwordx4 v[196:199], v249, s[20:23], s38 offen sc1
    s_add_u32 s37, s8, 4194304
    buffer_store_dwordx4 v[200:203], v250, s[20:23], s37 offen sc1
    buffer_store_dwordx4 v[204:207], v250, s[20:23], s37 offen offset:512 sc1
    s_add_u32 s37, s8, 4194304
    s_add_u32 s37, s37, s9
    buffer_store_dwordx4 v[208:211], v250, s[20:23], s37 offen sc1
    buffer_store_dwordx4 v[212:215], v250, s[20:23], s37 offen offset:512 sc1
concat_heads__sliding_local_dilated__mha_block__prompt_kernel_nodef:
    s_setprio 3
    s_waitcnt lgkmcnt(0)
    v_exp_f32 v64, v64
    v_exp_f32 v65, v65
    v_smfmac_f32_32x32x32_bf16 v[16:31], v[104:107], v[56:63], v108
    ds_read_b128 v[80:83], v109 offset:16384
    s_mov_b64 exec, s[44:45]
    ds_read_b128 v[100:103], v110 offset:15360
    ds_read_b128 v[104:107], v111 offset:15360
    s_mov_b64 exec, -1
    v_exp_f32 v66, v66
    v_exp_f32 v67, v67
    v_exp_f32 v68, v68
    v_exp_f32 v69, v69
    v_exp_f32 v70, v70
    v_mfma_f32_32x32x16_bf16 v[32:47], v[84:87], v[4:7], 0
    v_exp_f32 v71, v71
    v_exp_f32 v72, v72
    v_exp_f32 v73, v73
    v_exp_f32 v74, v74
    v_smfmac_f32_32x32x32_bf16 v[16:31], v[92:95], v[64:71], v108
    v_exp_f32 v75, v75
    v_exp_f32 v76, v76
    v_exp_f32 v77, v77
    v_exp_f32 v78, v78
    v_exp_f32 v79, v79
    s_waitcnt lgkmcnt(0)
    s_nop 0
    v_exp_f32 v32, v32
    v_exp_f32 v33, v33
    v_smfmac_f32_32x32x32_bf16 v[16:31], v[96:99], v[72:79], v108
    ds_read_b128 v[84:87], v109 offset:17408
    s_mov_b64 exec, s[44:45]
    ds_read_b128 v[92:95], v110 offset:16384
    ds_read_b128 v[96:99], v111 offset:16384
    s_mov_b64 exec, -1
    v_exp_f32 v34, v34
    v_exp_f32 v35, v35
    v_exp_f32 v36, v36
    v_exp_f32 v37, v37
    v_exp_f32 v38, v38
    v_mfma_f32_32x32x16_bf16 v[48:63], v[80:83], v[4:7], 0
    v_exp_f32 v39, v39
    v_exp_f32 v40, v40
    v_exp_f32 v41, v41
    v_exp_f32 v42, v42
    v_smfmac_f32_32x32x32_bf16 v[16:31], v[100:103], v[32:39], v108
    v_exp_f32 v43, v43
    v_exp_f32 v44, v44
    v_exp_f32 v45, v45
    v_exp_f32 v46, v46
    v_exp_f32 v47, v47
    s_waitcnt lgkmcnt(0)
    s_nop 0
    v_exp_f32 v48, v48
    v_exp_f32 v49, v49
    v_smfmac_f32_32x32x32_bf16 v[16:31], v[104:107], v[40:47], v108
    ds_read_b128 v[80:83], v109 offset:18432
    s_mov_b64 exec, s[44:45]
    ds_read_b128 v[100:103], v110 offset:17408
    ds_read_b128 v[104:107], v111 offset:17408
    s_mov_b64 exec, -1
    v_exp_f32 v50, v50
    v_exp_f32 v51, v51
    v_exp_f32 v52, v52
    v_exp_f32 v53, v53
    v_exp_f32 v54, v54
    v_mfma_f32_32x32x16_bf16 v[64:79], v[84:87], v[4:7], 0
    v_exp_f32 v55, v55
    v_exp_f32 v56, v56
    v_exp_f32 v57, v57
    v_exp_f32 v58, v58
    v_smfmac_f32_32x32x32_bf16 v[16:31], v[92:95], v[48:55], v108
    v_exp_f32 v59, v59
    v_exp_f32 v60, v60
    v_exp_f32 v61, v61
    v_exp_f32 v62, v62
    v_exp_f32 v63, v63
    s_waitcnt lgkmcnt(0)
    s_nop 0
    v_exp_f32 v64, v64
    v_exp_f32 v65, v65
    v_smfmac_f32_32x32x32_bf16 v[16:31], v[96:99], v[56:63], v108
    ds_read_b128 v[84:87], v109 offset:19456
    s_mov_b64 exec, s[44:45]
    ds_read_b128 v[92:95], v110 offset:18432
    ds_read_b128 v[96:99], v111 offset:18432
    s_mov_b64 exec, -1
    v_exp_f32 v66, v66
    v_exp_f32 v67, v67
    v_exp_f32 v68, v68
    v_exp_f32 v69, v69
    v_exp_f32 v70, v70
    v_mfma_f32_32x32x16_bf16 v[32:47], v[80:83], v[4:7], 0
    v_exp_f32 v71, v71
    v_exp_f32 v72, v72
    v_exp_f32 v73, v73
    v_exp_f32 v74, v74
    v_smfmac_f32_32x32x32_bf16 v[16:31], v[100:103], v[64:71], v108
    v_exp_f32 v75, v75
    v_exp_f32 v76, v76
    v_exp_f32 v77, v77
    v_exp_f32 v78, v78
    v_exp_f32 v79, v79
    s_waitcnt lgkmcnt(0)
    s_nop 0
    v_exp_f32 v32, v32
    v_exp_f32 v33, v33
    v_smfmac_f32_32x32x32_bf16 v[16:31], v[104:107], v[72:79], v108
    ds_read_b128 v[80:83], v109 offset:20480
    s_mov_b64 exec, s[44:45]
    ds_read_b128 v[100:103], v110 offset:19456
    ds_read_b128 v[104:107], v111 offset:19456
    s_mov_b64 exec, -1
    v_exp_f32 v34, v34
    v_exp_f32 v35, v35
    v_exp_f32 v36, v36
    v_exp_f32 v37, v37
    v_exp_f32 v38, v38
    v_mfma_f32_32x32x16_bf16 v[48:63], v[84:87], v[4:7], 0
    v_exp_f32 v39, v39
    v_exp_f32 v40, v40
    v_exp_f32 v41, v41
    v_exp_f32 v42, v42
    v_smfmac_f32_32x32x32_bf16 v[16:31], v[92:95], v[32:39], v108
    v_exp_f32 v43, v43
    v_exp_f32 v44, v44
    v_exp_f32 v45, v45
    v_exp_f32 v46, v46
    v_exp_f32 v47, v47
    s_waitcnt lgkmcnt(0)
    s_nop 0
    v_exp_f32 v48, v48
    v_exp_f32 v49, v49
    v_smfmac_f32_32x32x32_bf16 v[16:31], v[96:99], v[40:47], v108
    ds_read_b128 v[84:87], v109 offset:21504
    s_mov_b64 exec, s[44:45]
    ds_read_b128 v[92:95], v110 offset:20480
    ds_read_b128 v[96:99], v111 offset:20480
    s_mov_b64 exec, -1
    v_exp_f32 v50, v50
    v_exp_f32 v51, v51
    v_exp_f32 v52, v52
    v_exp_f32 v53, v53
    v_exp_f32 v54, v54
    v_mfma_f32_32x32x16_bf16 v[64:79], v[80:83], v[4:7], 0
    v_exp_f32 v55, v55
    v_exp_f32 v56, v56
    v_exp_f32 v57, v57
    v_exp_f32 v58, v58
    v_smfmac_f32_32x32x32_bf16 v[16:31], v[100:103], v[48:55], v108
    v_exp_f32 v59, v59
    v_exp_f32 v60, v60
    v_exp_f32 v61, v61
    v_exp_f32 v62, v62
    v_exp_f32 v63, v63
    s_waitcnt lgkmcnt(0)
    s_nop 0
    v_exp_f32 v64, v64
    v_exp_f32 v65, v65
    v_smfmac_f32_32x32x32_bf16 v[16:31], v[104:107], v[56:63], v108
    ds_read_b128 v[80:83], v109 offset:22528
    s_mov_b64 exec, s[44:45]
    ds_read_b128 v[100:103], v110 offset:21504
    ds_read_b128 v[104:107], v111 offset:21504
    s_mov_b64 exec, -1
    v_exp_f32 v66, v66
    v_exp_f32 v67, v67
    v_exp_f32 v68, v68
    v_exp_f32 v69, v69
    v_exp_f32 v70, v70
    v_mfma_f32_32x32x16_bf16 v[32:47], v[84:87], v[4:7], 0
    v_exp_f32 v71, v71
    v_exp_f32 v72, v72
    v_exp_f32 v73, v73
    v_exp_f32 v74, v74
    v_smfmac_f32_32x32x32_bf16 v[16:31], v[92:95], v[64:71], v108
    v_exp_f32 v75, v75
    v_exp_f32 v76, v76
    v_exp_f32 v77, v77
    v_exp_f32 v78, v78
    v_exp_f32 v79, v79
    s_waitcnt lgkmcnt(0)
    s_nop 0
    v_exp_f32 v32, v32
    v_exp_f32 v33, v33
    v_smfmac_f32_32x32x32_bf16 v[16:31], v[96:99], v[72:79], v108
    ds_read_b128 v[84:87], v109 offset:23552
    s_mov_b64 exec, s[44:45]
    ds_read_b128 v[92:95], v110 offset:22528
    ds_read_b128 v[96:99], v111 offset:22528
    s_mov_b64 exec, -1
    v_exp_f32 v34, v34
    v_exp_f32 v35, v35
    v_exp_f32 v36, v36
    v_exp_f32 v37, v37
    v_exp_f32 v38, v38
    v_mfma_f32_32x32x16_bf16 v[48:63], v[80:83], v[4:7], 0
    v_exp_f32 v39, v39
    v_exp_f32 v40, v40
    v_exp_f32 v41, v41
    v_exp_f32 v42, v42
    v_smfmac_f32_32x32x32_bf16 v[16:31], v[100:103], v[32:39], v108
    v_exp_f32 v43, v43
    v_exp_f32 v44, v44
    v_exp_f32 v45, v45
    v_exp_f32 v46, v46
    v_exp_f32 v47, v47
    s_waitcnt lgkmcnt(0)
    s_nop 0
    v_exp_f32 v48, v48
    v_exp_f32 v49, v49
    v_smfmac_f32_32x32x32_bf16 v[16:31], v[104:107], v[40:47], v108
    ds_read_b128 v[80:83], v109 offset:24576
    s_mov_b64 exec, s[44:45]
    ds_read_b128 v[100:103], v110 offset:23552
    ds_read_b128 v[104:107], v111 offset:23552
    s_mov_b64 exec, -1
    v_exp_f32 v50, v50
    v_exp_f32 v51, v51
    v_exp_f32 v52, v52
    v_exp_f32 v53, v53
    v_exp_f32 v54, v54
    v_mfma_f32_32x32x16_bf16 v[64:79], v[84:87], v[4:7], 0
    v_exp_f32 v55, v55
    v_exp_f32 v56, v56
    v_exp_f32 v57, v57
    v_exp_f32 v58, v58
    v_smfmac_f32_32x32x32_bf16 v[16:31], v[92:95], v[48:55], v108
    v_exp_f32 v59, v59
    v_exp_f32 v60, v60
    v_exp_f32 v61, v61
    v_exp_f32 v62, v62
    v_exp_f32 v63, v63
    s_setprio 2
    s_waitcnt lgkmcnt(0)
    v_exp_f32 v64, v64
    v_exp_f32 v65, v65
    v_smfmac_f32_32x32x32_bf16 v[16:31], v[96:99], v[56:63], v108
    ds_read_b128 v[84:87], v109 offset:25600
    s_mov_b64 exec, s[44:45]
    ds_read_b128 v[92:95], v110 offset:24576
    ds_read_b128 v[96:99], v111 offset:24576
    s_mov_b64 exec, -1
    v_exp_f32 v66, v66
    v_exp_f32 v67, v67
    v_exp_f32 v68, v68
    v_exp_f32 v69, v69
    v_exp_f32 v70, v70
    v_mfma_f32_32x32x16_bf16 v[32:47], v[80:83], v[4:7], 0
    v_exp_f32 v71, v71
    v_exp_f32 v72, v72
    v_exp_f32 v73, v73
    v_exp_f32 v74, v74
    v_smfmac_f32_32x32x32_bf16 v[16:31], v[100:103], v[64:71], v108
    v_exp_f32 v75, v75
    v_exp_f32 v76, v76
    v_exp_f32 v77, v77
    v_exp_f32 v78, v78
    v_exp_f32 v79, v79
    s_waitcnt lgkmcnt(0)
    s_nop 0
    v_exp_f32 v32, v32
    v_exp_f32 v33, v33
    v_smfmac_f32_32x32x32_bf16 v[16:31], v[104:107], v[72:79], v108
    ds_read_b128 v[80:83], v109 offset:26624
    s_mov_b64 exec, s[44:45]
    ds_read_b128 v[100:103], v110 offset:25600
    ds_read_b128 v[104:107], v111 offset:25600
    s_mov_b64 exec, -1
    v_exp_f32 v34, v34
    v_exp_f32 v35, v35
    v_exp_f32 v36, v36
    v_exp_f32 v37, v37
    v_exp_f32 v38, v38
    v_mfma_f32_32x32x16_bf16 v[48:63], v[84:87], v[4:7], 0
    v_exp_f32 v39, v39
    v_exp_f32 v40, v40
    v_exp_f32 v41, v41
    v_exp_f32 v42, v42
    v_smfmac_f32_32x32x32_bf16 v[16:31], v[92:95], v[32:39], v108
    v_exp_f32 v43, v43
    v_exp_f32 v44, v44
    v_exp_f32 v45, v45
    v_exp_f32 v46, v46
    v_exp_f32 v47, v47
    s_waitcnt lgkmcnt(0)
    s_nop 0
    v_exp_f32 v48, v48
    v_exp_f32 v49, v49
    v_smfmac_f32_32x32x32_bf16 v[16:31], v[96:99], v[40:47], v108
    ds_read_b128 v[84:87], v109 offset:27648
    s_mov_b64 exec, s[44:45]
    ds_read_b128 v[92:95], v110 offset:26624
    ds_read_b128 v[96:99], v111 offset:26624
    s_mov_b64 exec, -1
    v_exp_f32 v50, v50
    v_exp_f32 v51, v51
    v_exp_f32 v52, v52
    v_exp_f32 v53, v53
    v_exp_f32 v54, v54
    v_mfma_f32_32x32x16_bf16 v[64:79], v[80:83], v[4:7], 0
    v_exp_f32 v55, v55
    v_exp_f32 v56, v56
    v_exp_f32 v57, v57
    v_exp_f32 v58, v58
    v_smfmac_f32_32x32x32_bf16 v[16:31], v[100:103], v[48:55], v108
    v_exp_f32 v59, v59
    v_exp_f32 v60, v60
    v_exp_f32 v61, v61
    v_exp_f32 v62, v62
    v_exp_f32 v63, v63
    s_waitcnt lgkmcnt(0)
    s_nop 0
    v_exp_f32 v64, v64
    v_exp_f32 v65, v65
    v_smfmac_f32_32x32x32_bf16 v[16:31], v[104:107], v[56:63], v108
    ds_read_b128 v[80:83], v109 offset:28672
    s_mov_b64 exec, s[44:45]
    ds_read_b128 v[100:103], v110 offset:27648
    ds_read_b128 v[104:107], v111 offset:27648
    s_mov_b64 exec, -1
    v_exp_f32 v66, v66
    v_exp_f32 v67, v67
    v_exp_f32 v68, v68
    v_exp_f32 v69, v69
    v_exp_f32 v70, v70
    v_mfma_f32_32x32x16_bf16 v[32:47], v[84:87], v[4:7], 0
    v_exp_f32 v71, v71
    v_exp_f32 v72, v72
    v_exp_f32 v73, v73
    v_exp_f32 v74, v74
    v_smfmac_f32_32x32x32_bf16 v[16:31], v[92:95], v[64:71], v108
    v_exp_f32 v75, v75
    v_exp_f32 v76, v76
    v_exp_f32 v77, v77
    v_exp_f32 v78, v78
    v_exp_f32 v79, v79
    s_setprio 1
    s_waitcnt lgkmcnt(0)
    v_exp_f32 v32, v32
    v_exp_f32 v33, v33
    v_smfmac_f32_32x32x32_bf16 v[16:31], v[96:99], v[72:79], v108
    ds_read_b128 v[84:87], v109 offset:29696
    s_mov_b64 exec, s[44:45]
    ds_read_b128 v[92:95], v110 offset:28672
    ds_read_b128 v[96:99], v111 offset:28672
    s_mov_b64 exec, -1
    v_exp_f32 v34, v34
    v_exp_f32 v35, v35
    v_exp_f32 v36, v36
    v_exp_f32 v37, v37
    v_exp_f32 v38, v38
    v_mfma_f32_32x32x16_bf16 v[48:63], v[80:83], v[4:7], 0
    v_exp_f32 v39, v39
    v_exp_f32 v40, v40
    v_exp_f32 v41, v41
    v_exp_f32 v42, v42
    v_smfmac_f32_32x32x32_bf16 v[16:31], v[100:103], v[32:39], v108
    v_exp_f32 v43, v43
    v_exp_f32 v44, v44
    v_exp_f32 v45, v45
    v_exp_f32 v46, v46
    v_exp_f32 v47, v47
    s_waitcnt lgkmcnt(0)
    s_nop 0
    v_exp_f32 v48, v48
    v_exp_f32 v49, v49
    v_smfmac_f32_32x32x32_bf16 v[16:31], v[104:107], v[40:47], v108
    ds_read_b128 v[80:83], v109 offset:30720
    s_mov_b64 exec, s[44:45]
    ds_read_b128 v[100:103], v110 offset:29696
    ds_read_b128 v[104:107], v111 offset:29696
    s_mov_b64 exec, -1
    v_exp_f32 v50, v50
    v_exp_f32 v51, v51
    v_exp_f32 v52, v52
    v_exp_f32 v53, v53
    v_exp_f32 v54, v54
    v_mfma_f32_32x32x16_bf16 v[64:79], v[84:87], v[4:7], 0
    v_exp_f32 v55, v55
    v_exp_f32 v56, v56
    v_exp_f32 v57, v57
    v_exp_f32 v58, v58
    v_smfmac_f32_32x32x32_bf16 v[16:31], v[92:95], v[48:55], v108
    v_exp_f32 v59, v59
    v_exp_f32 v60, v60
    v_exp_f32 v61, v61
    v_exp_f32 v62, v62
    v_exp_f32 v63, v63
    s_setprio 0
    s_waitcnt lgkmcnt(0)
    v_exp_f32 v64, v64
    v_exp_f32 v65, v65
    v_smfmac_f32_32x32x32_bf16 v[16:31], v[96:99], v[56:63], v108
    ds_read_b128 v[84:87], v109 offset:31744
    s_mov_b64 exec, s[44:45]
    ds_read_b128 v[92:95], v110 offset:30720
    ds_read_b128 v[96:99], v111 offset:30720
    s_mov_b64 exec, -1
    v_exp_f32 v66, v66
    v_exp_f32 v67, v67
    v_exp_f32 v68, v68
    v_exp_f32 v69, v69
    v_exp_f32 v70, v70
    v_mfma_f32_32x32x16_bf16 v[32:47], v[80:83], v[4:7], 0
    v_exp_f32 v71, v71
    v_exp_f32 v72, v72
    v_exp_f32 v73, v73
    v_exp_f32 v74, v74
    v_smfmac_f32_32x32x32_bf16 v[16:31], v[100:103], v[64:71], v108
    v_exp_f32 v75, v75
    v_exp_f32 v76, v76
    v_exp_f32 v77, v77
    v_exp_f32 v78, v78
    v_exp_f32 v79, v79
    s_waitcnt vmcnt(0)
    s_barrier
    s_cmp_eq_u32 s33, 7
    s_cselect_b32 s49, s32, 0
    s_cmp_eq_u32 s49, 1
    s_cbranch_scc0 concat_heads__sliding_local_dilated__mha_block__prompt_kernel_noflaga
    v_mov_b32 v136, s3
    v_mov_b32 v137, s10
    s_mov_b64 exec, 1
    buffer_store_dword v136, v137, s[20:23], 0 offen sc1
    s_mov_b64 exec, -1
concat_heads__sliding_local_dilated__mha_block__prompt_kernel_noflaga:
    s_setprio 3
    s_waitcnt lgkmcnt(0)
    v_exp_f32 v32, v32
    v_exp_f32 v33, v33
    v_smfmac_f32_32x32x32_bf16 v[16:31], v[104:107], v[72:79], v108
    ds_read_b128 v[80:83], v109 offset:32768
    s_mov_b64 exec, s[44:45]
    ds_read_b128 v[100:103], v110 offset:31744
    ds_read_b128 v[104:107], v111 offset:31744
    s_mov_b64 exec, -1
    v_exp_f32 v34, v34
    v_exp_f32 v35, v35
    v_exp_f32 v36, v36
    v_exp_f32 v37, v37
    v_exp_f32 v38, v38
    v_mfma_f32_32x32x16_bf16 v[48:63], v[84:87], v[4:7], 0
    v_exp_f32 v39, v39
    v_exp_f32 v40, v40
    v_exp_f32 v41, v41
    v_exp_f32 v42, v42
    v_smfmac_f32_32x32x32_bf16 v[16:31], v[92:95], v[32:39], v108
    v_exp_f32 v43, v43
    v_exp_f32 v44, v44
    v_exp_f32 v45, v45
    v_exp_f32 v46, v46
    v_exp_f32 v47, v47
    s_waitcnt lgkmcnt(0)
    s_nop 0
    v_exp_f32 v48, v48
    v_exp_f32 v49, v49
    v_smfmac_f32_32x32x32_bf16 v[16:31], v[96:99], v[40:47], v108
    ds_read_b128 v[84:87], v109 offset:33792
    s_mov_b64 exec, s[44:45]
    ds_read_b128 v[92:95], v110 offset:32768
    ds_read_b128 v[96:99], v111 offset:32768
    s_mov_b64 exec, -1
    v_exp_f32 v50, v50
    v_exp_f32 v51, v51
    v_exp_f32 v52, v52
    v_exp_f32 v53, v53
    v_exp_f32 v54, v54
    v_mfma_f32_32x32x16_bf16 v[64:79], v[80:83], v[4:7], 0
    v_exp_f32 v55, v55
    v_exp_f32 v56, v56
    v_exp_f32 v57, v57
    v_exp_f32 v58, v58
    v_smfmac_f32_32x32x32_bf16 v[16:31], v[100:103], v[48:55], v108
    v_exp_f32 v59, v59
    v_exp_f32 v60, v60
    v_exp_f32 v61, v61
    v_exp_f32 v62, v62
    v_exp_f32 v63, v63
    s_waitcnt lgkmcnt(0)
    s_nop 0
    v_exp_f32 v64, v64
    v_exp_f32 v65, v65
    v_smfmac_f32_32x32x32_bf16 v[16:31], v[104:107], v[56:63], v108
    ds_read_b128 v[80:83], v109 offset:34816
    s_mov_b64 exec, s[44:45]
    ds_read_b128 v[100:103], v110 offset:33792
    ds_read_b128 v[104:107], v111 offset:33792
    s_mov_b64 exec, -1
    v_exp_f32 v66, v66
    v_exp_f32 v67, v67
    v_exp_f32 v68, v68
    v_exp_f32 v69, v69
    v_exp_f32 v70, v70
    v_mfma_f32_32x32x16_bf16 v[32:47], v[84:87], v[4:7], 0
    v_exp_f32 v71, v71
    v_exp_f32 v72, v72
    v_exp_f32 v73, v73
    v_exp_f32 v74, v74
    v_smfmac_f32_32x32x32_bf16 v[16:31], v[92:95], v[64:71], v108
    v_exp_f32 v75, v75
    v_exp_f32 v76, v76
    v_exp_f32 v77, v77
    v_exp_f32 v78, v78
    v_exp_f32 v79, v79
    s_waitcnt lgkmcnt(0)
    s_nop 0
    v_exp_f32 v32, v32
    v_exp_f32 v33, v33
    v_smfmac_f32_32x32x32_bf16 v[16:31], v[96:99], v[72:79], v108
    ds_read_b128 v[84:87], v109 offset:35840
    s_mov_b64 exec, s[44:45]
    ds_read_b128 v[92:95], v110 offset:34816
    ds_read_b128 v[96:99], v111 offset:34816
    s_mov_b64 exec, -1
    v_exp_f32 v34, v34
    v_exp_f32 v35, v35
    v_exp_f32 v36, v36
    v_exp_f32 v37, v37
    v_exp_f32 v38, v38
    v_mfma_f32_32x32x16_bf16 v[48:63], v[80:83], v[4:7], 0
    v_exp_f32 v39, v39
    v_exp_f32 v40, v40
    v_exp_f32 v41, v41
    v_exp_f32 v42, v42
    v_smfmac_f32_32x32x32_bf16 v[16:31], v[100:103], v[32:39], v108
    v_exp_f32 v43, v43
    v_exp_f32 v44, v44
    v_exp_f32 v45, v45
    v_exp_f32 v46, v46
    v_exp_f32 v47, v47
    s_waitcnt lgkmcnt(0)
    s_nop 0
    v_exp_f32 v48, v48
    v_exp_f32 v49, v49
    v_smfmac_f32_32x32x32_bf16 v[16:31], v[104:107], v[40:47], v108
    ds_read_b128 v[80:83], v109 offset:36864
    s_mov_b64 exec, s[44:45]
    ds_read_b128 v[100:103], v110 offset:35840
    ds_read_b128 v[104:107], v111 offset:35840
    s_mov_b64 exec, -1
    v_exp_f32 v50, v50
    v_exp_f32 v51, v51
    v_exp_f32 v52, v52
    v_exp_f32 v53, v53
    v_exp_f32 v54, v54
    v_mfma_f32_32x32x16_bf16 v[64:79], v[84:87], v[4:7], 0
    v_exp_f32 v55, v55
    v_exp_f32 v56, v56
    v_exp_f32 v57, v57
    v_exp_f32 v58, v58
    v_smfmac_f32_32x32x32_bf16 v[16:31], v[92:95], v[48:55], v108
    v_exp_f32 v59, v59
    v_exp_f32 v60, v60
    v_exp_f32 v61, v61
    v_exp_f32 v62, v62
    v_exp_f32 v63, v63
    s_waitcnt lgkmcnt(0)
    s_nop 0
    v_exp_f32 v64, v64
    v_exp_f32 v65, v65
    v_smfmac_f32_32x32x32_bf16 v[16:31], v[96:99], v[56:63], v108
    ds_read_b128 v[84:87], v109 offset:37888
    s_mov_b64 exec, s[44:45]
    ds_read_b128 v[92:95], v110 offset:36864
    ds_read_b128 v[96:99], v111 offset:36864
    s_mov_b64 exec, -1
    v_exp_f32 v66, v66
    v_exp_f32 v67, v67
    v_exp_f32 v68, v68
    v_exp_f32 v69, v69
    v_exp_f32 v70, v70
    v_mfma_f32_32x32x16_bf16 v[32:47], v[80:83], v[4:7], 0
    v_exp_f32 v71, v71
    v_exp_f32 v72, v72
    v_exp_f32 v73, v73
    v_exp_f32 v74, v74
    v_smfmac_f32_32x32x32_bf16 v[16:31], v[100:103], v[64:71], v108
    v_exp_f32 v75, v75
    v_exp_f32 v76, v76
    v_exp_f32 v77, v77
    v_exp_f32 v78, v78
    v_exp_f32 v79, v79
    s_waitcnt lgkmcnt(0)
    s_nop 0
    v_exp_f32 v32, v32
    v_exp_f32 v33, v33
    v_smfmac_f32_32x32x32_bf16 v[16:31], v[104:107], v[72:79], v108
    ds_read_b128 v[80:83], v109 offset:38912
    s_mov_b64 exec, s[44:45]
    ds_read_b128 v[100:103], v110 offset:37888
    ds_read_b128 v[104:107], v111 offset:37888
    s_mov_b64 exec, -1
    v_exp_f32 v34, v34
    v_exp_f32 v35, v35
    v_exp_f32 v36, v36
    v_exp_f32 v37, v37
    v_exp_f32 v38, v38
    v_mfma_f32_32x32x16_bf16 v[48:63], v[84:87], v[4:7], 0
    v_exp_f32 v39, v39
    v_exp_f32 v40, v40
    v_exp_f32 v41, v41
    v_exp_f32 v42, v42
    v_smfmac_f32_32x32x32_bf16 v[16:31], v[92:95], v[32:39], v108
    v_exp_f32 v43, v43
    v_exp_f32 v44, v44
    v_exp_f32 v45, v45
    v_exp_f32 v46, v46
    v_exp_f32 v47, v47
    s_waitcnt lgkmcnt(0)
    s_nop 0
    v_exp_f32 v48, v48
    v_exp_f32 v49, v49
    v_smfmac_f32_32x32x32_bf16 v[16:31], v[96:99], v[40:47], v108
    ds_read_b128 v[84:87], v109 offset:39936
    s_mov_b64 exec, s[44:45]
    ds_read_b128 v[92:95], v110 offset:38912
    ds_read_b128 v[96:99], v111 offset:38912
    s_mov_b64 exec, -1
    v_exp_f32 v50, v50
    v_exp_f32 v51, v51
    v_exp_f32 v52, v52
    v_exp_f32 v53, v53
    v_exp_f32 v54, v54
    v_mfma_f32_32x32x16_bf16 v[64:79], v[80:83], v[4:7], 0
    v_exp_f32 v55, v55
    v_exp_f32 v56, v56
    v_exp_f32 v57, v57
    v_exp_f32 v58, v58
    v_smfmac_f32_32x32x32_bf16 v[16:31], v[100:103], v[48:55], v108
    v_exp_f32 v59, v59
    v_exp_f32 v60, v60
    v_exp_f32 v61, v61
    v_exp_f32 v62, v62
    v_exp_f32 v63, v63
    s_waitcnt lgkmcnt(0)
    s_nop 0
    v_exp_f32 v64, v64
    v_exp_f32 v65, v65
    v_smfmac_f32_32x32x32_bf16 v[16:31], v[104:107], v[56:63], v108
    ds_read_b128 v[80:83], v109 offset:40960
    s_mov_b64 exec, s[44:45]
    ds_read_b128 v[100:103], v110 offset:39936
    ds_read_b128 v[104:107], v111 offset:39936
    s_mov_b64 exec, -1
    v_exp_f32 v66, v66
    v_exp_f32 v67, v67
    v_exp_f32 v68, v68
    v_exp_f32 v69, v69
    v_exp_f32 v70, v70
    v_mfma_f32_32x32x16_bf16 v[32:47], v[84:87], v[4:7], 0
    v_exp_f32 v71, v71
    v_exp_f32 v72, v72
    v_exp_f32 v73, v73
    v_exp_f32 v74, v74
    v_smfmac_f32_32x32x32_bf16 v[16:31], v[92:95], v[64:71], v108
    v_exp_f32 v75, v75
    v_exp_f32 v76, v76
    v_exp_f32 v77, v77
    v_exp_f32 v78, v78
    v_exp_f32 v79, v79
    s_waitcnt lgkmcnt(0)
    s_nop 0
    v_exp_f32 v32, v32
    v_exp_f32 v33, v33
    v_smfmac_f32_32x32x32_bf16 v[16:31], v[96:99], v[72:79], v108
    ds_read_b128 v[84:87], v109 offset:41984
    s_mov_b64 exec, s[44:45]
    ds_read_b128 v[92:95], v110 offset:40960
    ds_read_b128 v[96:99], v111 offset:40960
    s_mov_b64 exec, -1
    v_exp_f32 v34, v34
    v_exp_f32 v35, v35
    v_exp_f32 v36, v36
    v_exp_f32 v37, v37
    v_exp_f32 v38, v38
    v_mfma_f32_32x32x16_bf16 v[48:63], v[80:83], v[4:7], 0
    v_exp_f32 v39, v39
    v_exp_f32 v40, v40
    v_exp_f32 v41, v41
    v_exp_f32 v42, v42
    v_smfmac_f32_32x32x32_bf16 v[16:31], v[100:103], v[32:39], v108
    v_exp_f32 v43, v43
    v_exp_f32 v44, v44
    v_exp_f32 v45, v45
    v_exp_f32 v46, v46
    v_exp_f32 v47, v47
    s_cmp_eq_u32 s33, 7
    s_cbranch_scc0 concat_heads__sliding_local_dilated__mha_block__prompt_kernel_nopa
    buffer_load_dword v136, v155, s[20:23], 0 offen sc1
concat_heads__sliding_local_dilated__mha_block__prompt_kernel_nopa:
    s_waitcnt lgkmcnt(0)
    v_exp_f32 v48, v48
    v_exp_f32 v49, v49
    v_smfmac_f32_32x32x32_bf16 v[16:31], v[104:107], v[40:47], v108
    ds_read_b128 v[80:83], v109 offset:43008
    s_mov_b64 exec, s[44:45]
    ds_read_b128 v[100:103], v110 offset:41984
    ds_read_b128 v[104:107], v111 offset:41984
    s_mov_b64 exec, -1
    v_exp_f32 v50, v50
    v_exp_f32 v51, v51
    v_exp_f32 v52, v52
    v_exp_f32 v53, v53
    v_exp_f32 v54, v54
    v_mfma_f32_32x32x16_bf16 v[64:79], v[84:87], v[4:7], 0
    v_exp_f32 v55, v55
    v_exp_f32 v56, v56
    v_exp_f32 v57, v57
    v_exp_f32 v58, v58
    v_smfmac_f32_32x32x32_bf16 v[16:31], v[92:95], v[48:55], v108
    v_exp_f32 v59, v59
    v_exp_f32 v60, v60
    v_exp_f32 v61, v61
    v_exp_f32 v62, v62
    v_exp_f32 v63, v63
    s_setprio 2
    s_waitcnt lgkmcnt(0)
    v_exp_f32 v64, v64
    v_exp_f32 v65, v65
    v_smfmac_f32_32x32x32_bf16 v[16:31], v[96:99], v[56:63], v108
    ds_read_b128 v[84:87], v109 offset:44032
    s_mov_b64 exec, s[44:45]
    ds_read_b128 v[92:95], v110 offset:43008
    ds_read_b128 v[96:99], v111 offset:43008
    s_mov_b64 exec, -1
    v_exp_f32 v66, v66
    v_exp_f32 v67, v67
    v_exp_f32 v68, v68
    v_exp_f32 v69, v69
    v_exp_f32 v70, v70
    v_mfma_f32_32x32x16_bf16 v[32:47], v[80:83], v[4:7], 0
    v_exp_f32 v71, v71
    v_exp_f32 v72, v72
    v_exp_f32 v73, v73
    v_exp_f32 v74, v74
    v_smfmac_f32_32x32x32_bf16 v[16:31], v[100:103], v[64:71], v108
    v_exp_f32 v75, v75
    v_exp_f32 v76, v76
    v_exp_f32 v77, v77
    v_exp_f32 v78, v78
    v_exp_f32 v79, v79
    s_waitcnt lgkmcnt(0)
    s_nop 0
    v_exp_f32 v32, v32
    v_exp_f32 v33, v33
    v_smfmac_f32_32x32x32_bf16 v[16:31], v[104:107], v[72:79], v108
    ds_read_b128 v[80:83], v109 offset:45056
    s_mov_b64 exec, s[44:45]
    ds_read_b128 v[100:103], v110 offset:44032
    ds_read_b128 v[104:107], v111 offset:44032
    s_mov_b64 exec, -1
    v_exp_f32 v34, v34
    v_exp_f32 v35, v35
    v_exp_f32 v36, v36
    v_exp_f32 v37, v37
    v_exp_f32 v38, v38
    v_mfma_f32_32x32x16_bf16 v[48:63], v[84:87], v[4:7], 0
    v_exp_f32 v39, v39
    v_exp_f32 v40, v40
    v_exp_f32 v41, v41
    v_exp_f32 v42, v42
    v_smfmac_f32_32x32x32_bf16 v[16:31], v[92:95], v[32:39], v108
    v_exp_f32 v43, v43
    v_exp_f32 v44, v44
    v_exp_f32 v45, v45
    v_exp_f32 v46, v46
    v_exp_f32 v47, v47
    s_waitcnt lgkmcnt(0)
    s_nop 0
    v_exp_f32 v48, v48
    v_exp_f32 v49, v49
    v_smfmac_f32_32x32x32_bf16 v[16:31], v[96:99], v[40:47], v108
    ds_read_b128 v[84:87], v109 offset:46080
    s_mov_b64 exec, s[44:45]
    ds_read_b128 v[92:95], v110 offset:45056
    ds_read_b128 v[96:99], v111 offset:45056
    s_mov_b64 exec, -1
    v_exp_f32 v50, v50
    v_exp_f32 v51, v51
    v_exp_f32 v52, v52
    v_exp_f32 v53, v53
    v_exp_f32 v54, v54
    v_mfma_f32_32x32x16_bf16 v[64:79], v[80:83], v[4:7], 0
    v_exp_f32 v55, v55
    v_exp_f32 v56, v56
    v_exp_f32 v57, v57
    v_exp_f32 v58, v58
    v_smfmac_f32_32x32x32_bf16 v[16:31], v[100:103], v[48:55], v108
    v_exp_f32 v59, v59
    v_exp_f32 v60, v60
    v_exp_f32 v61, v61
    v_exp_f32 v62, v62
    v_exp_f32 v63, v63
    s_waitcnt lgkmcnt(0)
    s_nop 0
    v_exp_f32 v64, v64
    v_exp_f32 v65, v65
    v_smfmac_f32_32x32x32_bf16 v[16:31], v[104:107], v[56:63], v108
    ds_read_b128 v[80:83], v109 offset:47104
    s_mov_b64 exec, s[44:45]
    ds_read_b128 v[100:103], v110 offset:46080
    ds_read_b128 v[104:107], v111 offset:46080
    s_mov_b64 exec, -1
    v_exp_f32 v66, v66
    v_exp_f32 v67, v67
    v_exp_f32 v68, v68
    v_exp_f32 v69, v69
    v_exp_f32 v70, v70
    v_mfma_f32_32x32x16_bf16 v[32:47], v[84:87], v[4:7], 0
    v_exp_f32 v71, v71
    v_exp_f32 v72, v72
    v_exp_f32 v73, v73
    v_exp_f32 v74, v74
    v_smfmac_f32_32x32x32_bf16 v[16:31], v[92:95], v[64:71], v108
    v_exp_f32 v75, v75
    v_exp_f32 v76, v76
    v_exp_f32 v77, v77
    v_exp_f32 v78, v78
    v_exp_f32 v79, v79
    s_setprio 1
    s_waitcnt lgkmcnt(0)
    v_exp_f32 v32, v32
    v_exp_f32 v33, v33
    v_smfmac_f32_32x32x32_bf16 v[16:31], v[96:99], v[72:79], v108
    ds_read_b128 v[84:87], v109 offset:48128
    s_mov_b64 exec, s[44:45]
    ds_read_b128 v[92:95], v110 offset:47104
    ds_read_b128 v[96:99], v111 offset:47104
    s_mov_b64 exec, -1
    v_exp_f32 v34, v34
    v_exp_f32 v35, v35
    v_exp_f32 v36, v36
    v_exp_f32 v37, v37
    v_exp_f32 v38, v38
    v_mfma_f32_32x32x16_bf16 v[48:63], v[80:83], v[4:7], 0
    v_exp_f32 v39, v39
    v_exp_f32 v40, v40
    v_exp_f32 v41, v41
    v_exp_f32 v42, v42
    v_smfmac_f32_32x32x32_bf16 v[16:31], v[100:103], v[32:39], v108
    v_exp_f32 v43, v43
    v_exp_f32 v44, v44
    v_exp_f32 v45, v45
    v_exp_f32 v46, v46
    v_exp_f32 v47, v47
    s_waitcnt lgkmcnt(0)
    s_nop 0
    v_exp_f32 v48, v48
    v_exp_f32 v49, v49
    v_smfmac_f32_32x32x32_bf16 v[16:31], v[104:107], v[40:47], v108
    ds_read_b128 v[80:83], v109 offset:49152
    s_mov_b64 exec, s[44:45]
    ds_read_b128 v[100:103], v110 offset:48128
    ds_read_b128 v[104:107], v111 offset:48128
    s_mov_b64 exec, -1
    v_exp_f32 v50, v50
    v_exp_f32 v51, v51
    v_exp_f32 v52, v52
    v_exp_f32 v53, v53
    v_exp_f32 v54, v54
    v_mfma_f32_32x32x16_bf16 v[64:79], v[84:87], v[4:7], 0
    v_exp_f32 v55, v55
    v_exp_f32 v56, v56
    v_exp_f32 v57, v57
    v_exp_f32 v58, v58
    v_smfmac_f32_32x32x32_bf16 v[16:31], v[92:95], v[48:55], v108
    v_exp_f32 v59, v59
    v_exp_f32 v60, v60
    v_exp_f32 v61, v61
    v_exp_f32 v62, v62
    v_exp_f32 v63, v63
    s_setprio 0
    s_waitcnt lgkmcnt(0)
    v_exp_f32 v64, v64
    v_exp_f32 v65, v65
    v_smfmac_f32_32x32x32_bf16 v[16:31], v[96:99], v[56:63], v108
    ds_read_b128 v[84:87], v109 offset:50176
    s_mov_b64 exec, s[44:45]
    ds_read_b128 v[92:95], v110 offset:49152
    ds_read_b128 v[96:99], v111 offset:49152
    s_mov_b64 exec, -1
    v_exp_f32 v66, v66
    v_exp_f32 v67, v67
    v_exp_f32 v68, v68
    v_exp_f32 v69, v69
    v_exp_f32 v70, v70
    v_mfma_f32_32x32x16_bf16 v[32:47], v[80:83], v[4:7], 0
    v_exp_f32 v71, v71
    v_exp_f32 v72, v72
    v_exp_f32 v73, v73
    v_exp_f32 v74, v74
    v_smfmac_f32_32x32x32_bf16 v[16:31], v[100:103], v[64:71], v108
    v_exp_f32 v75, v75
    v_exp_f32 v76, v76
    v_exp_f32 v77, v77
    v_exp_f32 v78, v78
    v_exp_f32 v79, v79
    s_cmp_eq_u32 s33, 7
    s_cbranch_scc0 concat_heads__sliding_local_dilated__mha_block__prompt_kernel_nopb
    s_mov_b32 s51, 0
    s_branch concat_heads__sliding_local_dilated__mha_block__prompt_kernel_poll3_chk
concat_heads__sliding_local_dilated__mha_block__prompt_kernel_poll3:
    buffer_load_dword v136, v155, s[20:23], 0 offen sc1
concat_heads__sliding_local_dilated__mha_block__prompt_kernel_poll3_chk:
    s_waitcnt vmcnt(0)
    v_cmp_ne_u32 vcc, s3, v136
    s_cbranch_vccz concat_heads__sliding_local_dilated__mha_block__prompt_kernel_poll3_ok
    s_add_u32 s51, s51, 1
    s_cmp_lt_u32 s51, 32768
    s_cbranch_scc1 concat_heads__sliding_local_dilated__mha_block__prompt_kernel_poll3
concat_heads__sliding_local_dilated__mha_block__prompt_kernel_poll3_ok:
concat_heads__sliding_local_dilated__mha_block__prompt_kernel_nopb:
    s_barrier
    s_add_u32 s39, s35, 2097152
    s_add_u32 s40, s36, 2097152
    s_add_u32 s41, s35, 4194304
    s_add_u32 s42, s36, 4194304
    buffer_load_dwordx4 v[112:115], v2, s[20:23], s35 offen sc1
    buffer_load_dwordx4 v[116:119], v2, s[20:23], s39 offen sc1
    buffer_load_dwordx4 v[120:123], v2, s[20:23], s40 offen sc1
    s_mov_b32 s44, 0x0000ffff
    s_mov_b32 s45, 0x0000ffff
    s_mov_b64 exec, s[44:45]
    buffer_load_dwordx4 v[124:127], v153, s[20:23], s41 offen sc1
    buffer_load_dwordx4 v[128:131], v153, s[20:23], s41 offen offset:512 sc1
    buffer_load_dwordx4 v[132:135], v153, s[20:23], s42 offen offset:512 sc1
    s_mov_b64 exec, -1
    s_setprio 3
    s_waitcnt lgkmcnt(0)
    v_exp_f32 v32, v32
    v_exp_f32 v33, v33
    v_smfmac_f32_32x32x32_bf16 v[16:31], v[104:107], v[72:79], v108
    ds_read_b128 v[80:83], v109 offset:51200
    s_mov_b64 exec, s[44:45]
    ds_read_b128 v[100:103], v110 offset:50176
    ds_read_b128 v[104:107], v111 offset:50176
    s_mov_b64 exec, -1
    v_exp_f32 v34, v34
    v_exp_f32 v35, v35
    v_exp_f32 v36, v36
    v_exp_f32 v37, v37
    v_exp_f32 v38, v38
    v_mfma_f32_32x32x16_bf16 v[48:63], v[84:87], v[4:7], 0
    v_exp_f32 v39, v39
    v_exp_f32 v40, v40
    v_exp_f32 v41, v41
    v_exp_f32 v42, v42
    v_smfmac_f32_32x32x32_bf16 v[16:31], v[92:95], v[32:39], v108
    v_exp_f32 v43, v43
    v_exp_f32 v44, v44
    v_exp_f32 v45, v45
    v_exp_f32 v46, v46
    v_exp_f32 v47, v47
    s_waitcnt lgkmcnt(0)
    s_nop 0
    v_exp_f32 v48, v48
    v_exp_f32 v49, v49
    v_smfmac_f32_32x32x32_bf16 v[16:31], v[96:99], v[40:47], v108
    ds_read_b128 v[84:87], v109 offset:52224
    s_mov_b64 exec, s[44:45]
    ds_read_b128 v[92:95], v110 offset:51200
    ds_read_b128 v[96:99], v111 offset:51200
    s_mov_b64 exec, -1
    v_exp_f32 v50, v50
    v_exp_f32 v51, v51
    v_exp_f32 v52, v52
    v_exp_f32 v53, v53
    v_exp_f32 v54, v54
    v_mfma_f32_32x32x16_bf16 v[64:79], v[80:83], v[4:7], 0
    v_exp_f32 v55, v55
    v_exp_f32 v56, v56
    v_exp_f32 v57, v57
    v_exp_f32 v58, v58
    v_smfmac_f32_32x32x32_bf16 v[16:31], v[100:103], v[48:55], v108
    v_exp_f32 v59, v59
    v_exp_f32 v60, v60
    v_exp_f32 v61, v61
    v_exp_f32 v62, v62
    v_exp_f32 v63, v63
    s_waitcnt lgkmcnt(0)
    s_nop 0
    v_exp_f32 v64, v64
    v_exp_f32 v65, v65
    v_smfmac_f32_32x32x32_bf16 v[16:31], v[104:107], v[56:63], v108
    ds_read_b128 v[80:83], v109 offset:53248
    s_mov_b64 exec, s[44:45]
    ds_read_b128 v[100:103], v110 offset:52224
    ds_read_b128 v[104:107], v111 offset:52224
    s_mov_b64 exec, -1
    v_exp_f32 v66, v66
    v_exp_f32 v67, v67
    v_exp_f32 v68, v68
    v_exp_f32 v69, v69
    v_exp_f32 v70, v70
    v_mfma_f32_32x32x16_bf16 v[32:47], v[84:87], v[4:7], 0
    v_exp_f32 v71, v71
    v_exp_f32 v72, v72
    v_exp_f32 v73, v73
    v_exp_f32 v74, v74
    v_smfmac_f32_32x32x32_bf16 v[16:31], v[92:95], v[64:71], v108
    v_exp_f32 v75, v75
    v_exp_f32 v76, v76
    v_exp_f32 v77, v77
    v_exp_f32 v78, v78
    v_exp_f32 v79, v79
    s_waitcnt lgkmcnt(0)
    s_nop 0
    v_exp_f32 v32, v32
    v_exp_f32 v33, v33
    v_smfmac_f32_32x32x32_bf16 v[16:31], v[96:99], v[72:79], v108
    ds_read_b128 v[84:87], v109 offset:54272
    s_mov_b64 exec, s[44:45]
    ds_read_b128 v[92:95], v110 offset:53248
    ds_read_b128 v[96:99], v111 offset:53248
    s_mov_b64 exec, -1
    v_exp_f32 v34, v34
    v_exp_f32 v35, v35
    v_exp_f32 v36, v36
    v_exp_f32 v37, v37
    v_exp_f32 v38, v38
    v_mfma_f32_32x32x16_bf16 v[48:63], v[80:83], v[4:7], 0
    v_exp_f32 v39, v39
    v_exp_f32 v40, v40
    v_exp_f32 v41, v41
    v_exp_f32 v42, v42
    v_smfmac_f32_32x32x32_bf16 v[16:31], v[100:103], v[32:39], v108
    v_exp_f32 v43, v43
    v_exp_f32 v44, v44
    v_exp_f32 v45, v45
    v_exp_f32 v46, v46
    v_exp_f32 v47, v47
    s_waitcnt lgkmcnt(0)
    s_nop 0
    v_exp_f32 v48, v48
    v_exp_f32 v49, v49
    v_smfmac_f32_32x32x32_bf16 v[16:31], v[104:107], v[40:47], v108
    ds_read_b128 v[80:83], v109 offset:55296
    s_mov_b64 exec, s[44:45]
    ds_read_b128 v[100:103], v110 offset:54272
    ds_read_b128 v[104:107], v111 offset:54272
    s_mov_b64 exec, -1
    v_exp_f32 v50, v50
    v_exp_f32 v51, v51
    v_exp_f32 v52, v52
    v_exp_f32 v53, v53
    v_exp_f32 v54, v54
    v_mfma_f32_32x32x16_bf16 v[64:79], v[84:87], v[4:7], 0
    v_exp_f32 v55, v55
    v_exp_f32 v56, v56
    v_exp_f32 v57, v57
    v_exp_f32 v58, v58
    v_smfmac_f32_32x32x32_bf16 v[16:31], v[92:95], v[48:55], v108
    v_exp_f32 v59, v59
    v_exp_f32 v60, v60
    v_exp_f32 v61, v61
    v_exp_f32 v62, v62
    v_exp_f32 v63, v63
    s_waitcnt lgkmcnt(0)
    s_nop 0
    v_exp_f32 v64, v64
    v_exp_f32 v65, v65
    v_smfmac_f32_32x32x32_bf16 v[16:31], v[96:99], v[56:63], v108
    ds_read_b128 v[84:87], v109 offset:56320
    s_mov_b64 exec, s[44:45]
    ds_read_b128 v[92:95], v110 offset:55296
    ds_read_b128 v[96:99], v111 offset:55296
    s_mov_b64 exec, -1
    v_exp_f32 v66, v66
    v_exp_f32 v67, v67
    v_exp_f32 v68, v68
    v_exp_f32 v69, v69
    v_exp_f32 v70, v70
    v_mfma_f32_32x32x16_bf16 v[32:47], v[80:83], v[4:7], 0
    v_exp_f32 v71, v71
    v_exp_f32 v72, v72
    v_exp_f32 v73, v73
    v_exp_f32 v74, v74
    v_smfmac_f32_32x32x32_bf16 v[16:31], v[100:103], v[64:71], v108
    v_exp_f32 v75, v75
    v_exp_f32 v76, v76
    v_exp_f32 v77, v77
    v_exp_f32 v78, v78
    v_exp_f32 v79, v79
    s_waitcnt lgkmcnt(0)
    s_nop 0
    v_exp_f32 v32, v32
    v_exp_f32 v33, v33
    v_smfmac_f32_32x32x32_bf16 v[16:31], v[104:107], v[72:79], v108
    ds_read_b128 v[80:83], v109 offset:57344
    s_mov_b64 exec, s[44:45]
    ds_read_b128 v[100:103], v110 offset:56320
    ds_read_b128 v[104:107], v111 offset:56320
    s_mov_b64 exec, -1
    v_exp_f32 v34, v34
    v_exp_f32 v35, v35
    v_exp_f32 v36, v36
    v_exp_f32 v37, v37
    v_exp_f32 v38, v38
    v_mfma_f32_32x32x16_bf16 v[48:63], v[84:87], v[4:7], 0
    v_exp_f32 v39, v39
    v_exp_f32 v40, v40
    v_exp_f32 v41, v41
    v_exp_f32 v42, v42
    v_smfmac_f32_32x32x32_bf16 v[16:31], v[92:95], v[32:39], v108
    v_exp_f32 v43, v43
    v_exp_f32 v44, v44
    v_exp_f32 v45, v45
    v_exp_f32 v46, v46
    v_exp_f32 v47, v47
    s_waitcnt lgkmcnt(0)
    s_nop 0
    v_exp_f32 v48, v48
    v_exp_f32 v49, v49
    v_smfmac_f32_32x32x32_bf16 v[16:31], v[96:99], v[40:47], v108
    ds_read_b128 v[84:87], v109 offset:58368
    s_mov_b64 exec, s[44:45]
    ds_read_b128 v[92:95], v110 offset:57344
    ds_read_b128 v[96:99], v111 offset:57344
    s_mov_b64 exec, -1
    v_exp_f32 v50, v50
    v_exp_f32 v51, v51
    v_exp_f32 v52, v52
    v_exp_f32 v53, v53
    v_exp_f32 v54, v54
    v_mfma_f32_32x32x16_bf16 v[64:79], v[80:83], v[4:7], 0
    v_exp_f32 v55, v55
    v_exp_f32 v56, v56
    v_exp_f32 v57, v57
    v_exp_f32 v58, v58
    v_smfmac_f32_32x32x32_bf16 v[16:31], v[100:103], v[48:55], v108
    v_exp_f32 v59, v59
    v_exp_f32 v60, v60
    v_exp_f32 v61, v61
    v_exp_f32 v62, v62
    v_exp_f32 v63, v63
    v_mov_b32 v168, 0
    v_mov_b32 v169, 0
    v_mov_b32 v170, 0
    v_mov_b32 v171, 0
    v_mov_b32 v172, 0
    v_mov_b32 v173, 0
    v_mov_b32 v174, 0
    v_mov_b32 v175, 0
    v_mov_b32 v176, 0
    v_mov_b32 v177, 0
    v_mov_b32 v178, 0
    v_mov_b32 v179, 0
    v_mov_b32 v180, 0
    v_mov_b32 v181, 0
    v_mov_b32 v182, 0
    v_mov_b32 v183, 0
    s_waitcnt vmcnt(3)
    v_mfma_f32_32x32x16_bf16 v[216:231], v[116:119], v[112:115], v[216:231]
    v_mfma_f32_32x32x16_bf16 v[232:247], v[120:123], v[112:115], v[232:247]
    s_nop 7
    s_nop 2
    v_max3_f32 v154, v216, v217, v218
    v_max3_f32 v136, v219, v220, v221
    v_max3_f32 v154, v154, v222, v223
    v_max3_f32 v136, v136, v224, v225
    v_max3_f32 v154, v154, v226, v227
    v_max3_f32 v136, v136, v228, v229
    v_max3_f32 v154, v154, v230, v231
    v_max3_f32 v136, v136, v240, v241
    v_max3_f32 v154, v154, v242, v243
    v_max3_f32 v136, v136, v244, v245
    v_max3_f32 v154, v154, v246, v247
    v_max_f32 v154, v154, v136
    v_mov_b32 v136, v154
    s_nop 1
    v_permlane32_swap_b32 v136, v154
    v_max_f32 v154, v154, v136
    v_sub_f32 v216, v216, v154
    v_sub_f32 v217, v217, v154
    v_sub_f32 v218, v218, v154
    v_sub_f32 v219, v219, v154
    v_sub_f32 v220, v220, v154
    v_sub_f32 v221, v221, v154
    v_sub_f32 v222, v222, v154
    v_sub_f32 v223, v223, v154
    v_sub_f32 v224, v224, v154
    v_sub_f32 v225, v225, v154
    v_sub_f32 v226, v226, v154
    v_sub_f32 v227, v227, v154
    v_sub_f32 v228, v228, v154
    v_sub_f32 v229, v229, v154
    v_sub_f32 v230, v230, v154
    v_sub_f32 v231, v231, v154
    v_sub_f32 v240, v240, v154
    v_sub_f32 v241, v241, v154
    v_sub_f32 v242, v242, v154
    v_sub_f32 v243, v243, v154
    v_sub_f32 v244, v244, v154
    v_sub_f32 v245, v245, v154
    v_sub_f32 v246, v246, v154
    v_sub_f32 v247, v247, v154
    v_exp_f32 v216, v216
    v_exp_f32 v217, v217
    v_exp_f32 v218, v218
    v_exp_f32 v219, v219
    v_exp_f32 v220, v220
    v_exp_f32 v221, v221
    v_exp_f32 v222, v222
    v_exp_f32 v223, v223
    s_waitcnt vmcnt(0)
    v_exp_f32 v224, v224
    v_exp_f32 v225, v225
    v_smfmac_f32_32x32x32_bf16 v[168:183], v[124:127], v[216:223], v108
    v_exp_f32 v226, v226
    v_exp_f32 v227, v227
    v_exp_f32 v228, v228
    v_exp_f32 v229, v229
    v_exp_f32 v230, v230
    v_exp_f32 v231, v231
    v_exp_f32 v240, v240
    v_exp_f32 v241, v241
    v_smfmac_f32_32x32x32_bf16 v[168:183], v[128:131], v[224:231], v108
    v_exp_f32 v242, v242
    v_exp_f32 v243, v243
    v_exp_f32 v244, v244
    v_exp_f32 v245, v245
    v_exp_f32 v246, v246
    v_exp_f32 v247, v247
    s_nop 1
    v_smfmac_f32_32x32x32_bf16 v[168:183], v[132:135], v[240:247], v108
    s_add_u32 s39, s35, 6291456
    s_nop 7
    s_nop 2
    v_rcp_f32 v136, v176
    s_nop 0
    v_mul_f32 v168, v168, v136
    v_mul_f32 v169, v169, v136
    v_mul_f32 v170, v170, v136
    v_mul_f32 v171, v171, v136
    v_mul_f32 v172, v172, v136
    v_mul_f32 v173, v173, v136
    v_mul_f32 v174, v174, v136
    v_mul_f32 v175, v175, v136
    v_cvt_pk_bf16_f32 v140, v168, v169
    v_cvt_pk_bf16_f32 v141, v170, v171
    v_cvt_pk_bf16_f32 v142, v172, v173
    v_cvt_pk_bf16_f32 v143, v174, v175
    buffer_store_dwordx4 v[140:143], v2, s[20:23], s39 offen sc1
    s_waitcnt lgkmcnt(0)
    v_exp_f32 v64, v64
    v_exp_f32 v65, v65
    v_smfmac_f32_32x32x32_bf16 v[16:31], v[104:107], v[56:63], v108
    ds_read_b128 v[80:83], v109 offset:59392
    s_mov_b64 exec, s[44:45]
    ds_read_b128 v[100:103], v110 offset:58368
    ds_read_b128 v[104:107], v111 offset:58368
    s_mov_b64 exec, -1
    v_exp_f32 v66, v66
    v_exp_f32 v67, v67
    v_exp_f32 v68, v68
    v_exp_f32 v69, v69
    v_exp_f32 v70, v70
    v_mfma_f32_32x32x16_bf16 v[32:47], v[84:87], v[4:7], 0
    v_exp_f32 v71, v71
    v_exp_f32 v72, v72
    v_exp_f32 v73, v73
    v_exp_f32 v74, v74
    v_smfmac_f32_32x32x32_bf16 v[16:31], v[92:95], v[64:71], v108
    v_exp_f32 v75, v75
    v_exp_f32 v76, v76
    v_exp_f32 v77, v77
    v_exp_f32 v78, v78
    v_exp_f32 v79, v79
    s_setprio 2
    s_waitcnt lgkmcnt(0)
    v_exp_f32 v32, v32
    v_exp_f32 v33, v33
    v_smfmac_f32_32x32x32_bf16 v[16:31], v[96:99], v[72:79], v108
    ds_read_b128 v[84:87], v109 offset:60416
    s_mov_b64 exec, s[44:45]
    ds_read_b128 v[92:95], v110 offset:59392
    ds_read_b128 v[96:99], v111 offset:59392
    s_mov_b64 exec, -1
    v_exp_f32 v34, v34
    v_exp_f32 v35, v35
    v_exp_f32 v36, v36
    v_exp_f32 v37, v37
    v_exp_f32 v38, v38
    v_mfma_f32_32x32x16_bf16 v[48:63], v[80:83], v[4:7], 0
    v_exp_f32 v39, v39
    v_exp_f32 v40, v40
    v_exp_f32 v41, v41
    v_exp_f32 v42, v42
    v_smfmac_f32_32x32x32_bf16 v[16:31], v[100:103], v[32:39], v108
    v_exp_f32 v43, v43
    v_exp_f32 v44, v44
    v_exp_f32 v45, v45
    v_exp_f32 v46, v46
    v_exp_f32 v47, v47
    s_waitcnt lgkmcnt(0)
    s_nop 0
    v_exp_f32 v48, v48
    v_exp_f32 v49, v49
    v_smfmac_f32_32x32x32_bf16 v[16:31], v[104:107], v[40:47], v108
    ds_read_b128 v[80:83], v109 offset:61440
    s_mov_b64 exec, s[44:45]
    ds_read_b128 v[100:103], v110 offset:60416
    ds_read_b128 v[104:107], v111 offset:60416
    s_mov_b64 exec, -1
    v_exp_f32 v50, v50
    v_exp_f32 v51, v51
    v_exp_f32 v52, v52
    v_exp_f32 v53, v53
    v_exp_f32 v54, v54
    v_mfma_f32_32x32x16_bf16 v[64:79], v[84:87], v[4:7], 0
    v_exp_f32 v55, v55
    v_exp_f32 v56, v56
    v_exp_f32 v57, v57
    v_exp_f32 v58, v58
    v_smfmac_f32_32x32x32_bf16 v[16:31], v[92:95], v[48:55], v108
    v_exp_f32 v59, v59
    v_exp_f32 v60, v60
    v_exp_f32 v61, v61
    v_exp_f32 v62, v62
    v_exp_f32 v63, v63
    s_waitcnt lgkmcnt(0)
    s_nop 0
    v_exp_f32 v64, v64
    v_exp_f32 v65, v65
    v_smfmac_f32_32x32x32_bf16 v[16:31], v[96:99], v[56:63], v108
    ds_read_b128 v[84:87], v109 offset:62464
    s_mov_b64 exec, s[44:45]
    ds_read_b128 v[92:95], v110 offset:61440
    ds_read_b128 v[96:99], v111 offset:61440
    s_mov_b64 exec, -1
    v_exp_f32 v66, v66
    v_exp_f32 v67, v67
    v_exp_f32 v68, v68
    v_exp_f32 v69, v69
    v_exp_f32 v70, v70
    v_mfma_f32_32x32x16_bf16 v[32:47], v[80:83], v[4:7], 0
    v_exp_f32 v71, v71
    v_exp_f32 v72, v72
    v_exp_f32 v73, v73
    v_exp_f32 v74, v74
    v_smfmac_f32_32x32x32_bf16 v[16:31], v[100:103], v[64:71], v108
    v_exp_f32 v75, v75
    v_exp_f32 v76, v76
    v_exp_f32 v77, v77
    v_exp_f32 v78, v78
    v_exp_f32 v79, v79
    s_waitcnt lgkmcnt(0)
    s_nop 0
    v_exp_f32 v32, v32
    v_exp_f32 v33, v33
    v_smfmac_f32_32x32x32_bf16 v[16:31], v[104:107], v[72:79], v108
    ds_read_b128 v[80:83], v109 offset:63488
    s_mov_b64 exec, s[44:45]
    ds_read_b128 v[100:103], v110 offset:62464
    ds_read_b128 v[104:107], v111 offset:62464
    s_mov_b64 exec, -1
    v_exp_f32 v34, v34
    v_exp_f32 v35, v35
    v_exp_f32 v36, v36
    v_exp_f32 v37, v37
    v_exp_f32 v38, v38
    v_mfma_f32_32x32x16_bf16 v[48:63], v[84:87], v[4:7], 0
    v_exp_f32 v39, v39
    v_exp_f32 v40, v40
    v_exp_f32 v41, v41
    v_exp_f32 v42, v42
    v_smfmac_f32_32x32x32_bf16 v[16:31], v[92:95], v[32:39], v108
    v_exp_f32 v43, v43
    v_exp_f32 v44, v44
    v_exp_f32 v45, v45
    v_exp_f32 v46, v46
    v_exp_f32 v47, v47
    s_setprio 1
    s_waitcnt lgkmcnt(0)
    v_exp_f32 v48, v48
    v_exp_f32 v49, v49
    v_smfmac_f32_32x32x32_bf16 v[16:31], v[96:99], v[40:47], v108
    ds_read_b128 v[84:87], v109 offset:64512
    s_mov_b64 exec, s[44:45]
    ds_read_b128 v[92:95], v110 offset:63488
    ds_read_b128 v[96:99], v111 offset:63488
    s_mov_b64 exec, -1
    v_exp_f32 v50, v50
    v_exp_f32 v51, v51
    v_exp_f32 v52, v52
    v_exp_f32 v53, v53
    v_exp_f32 v54, v54
    v_mfma_f32_32x32x16_bf16 v[64:79], v[80:83], v[4:7], 0
    v_exp_f32 v55, v55
    v_exp_f32 v56, v56
    v_exp_f32 v57, v57
    v_exp_f32 v58, v58
    v_smfmac_f32_32x32x32_bf16 v[16:31], v[100:103], v[48:55], v108
    v_exp_f32 v59, v59
    v_exp_f32 v60, v60
    v_exp_f32 v61, v61
    v_exp_f32 v62, v62
    v_exp_f32 v63, v63
    s_waitcnt lgkmcnt(0)
    s_nop 0
    v_exp_f32 v64, v64
    v_exp_f32 v65, v65
    v_smfmac_f32_32x32x32_bf16 v[16:31], v[104:107], v[56:63], v108
    s_mov_b64 exec, s[44:45]
    ds_read_b128 v[100:103], v110 offset:64512
    ds_read_b128 v[104:107], v111 offset:64512
    s_mov_b64 exec, -1
    v_exp_f32 v66, v66
    v_exp_f32 v67, v67
    v_exp_f32 v68, v68
    v_exp_f32 v69, v69
    v_exp_f32 v70, v70
    v_mfma_f32_32x32x16_bf16 v[32:47], v[84:87], v[4:7], 0
    v_exp_f32 v71, v71
    v_exp_f32 v72, v72
    v_exp_f32 v73, v73
    v_exp_f32 v74, v74
    v_smfmac_f32_32x32x32_bf16 v[16:31], v[92:95], v[64:71], v108
    v_exp_f32 v75, v75
    v_exp_f32 v76, v76
    v_exp_f32 v77, v77
    v_exp_f32 v78, v78
    v_exp_f32 v79, v79
    s_setprio 0
    s_waitcnt lgkmcnt(0)
    v_exp_f32 v32, v32
    v_exp_f32 v33, v33
    v_smfmac_f32_32x32x32_bf16 v[16:31], v[96:99], v[72:79], v108
    v_exp_f32 v34, v34
    v_exp_f32 v35, v35
    v_exp_f32 v36, v36
    v_exp_f32 v37, v37
    v_exp_f32 v38, v38
    v_exp_f32 v39, v39
    v_exp_f32 v40, v40
    v_exp_f32 v41, v41
    v_exp_f32 v42, v42
    v_smfmac_f32_32x32x32_bf16 v[16:31], v[100:103], v[32:39], v108
    v_exp_f32 v43, v43
    v_exp_f32 v44, v44
    v_exp_f32 v45, v45
    v_exp_f32 v46, v46
    v_exp_f32 v47, v47
    s_nop 1
    v_smfmac_f32_32x32x32_bf16 v[16:31], v[104:107], v[40:47], v108
    s_load_dwordx2 s[4:5], s[0:1], 16
    s_load_dwordx2 s[6:7], s[0:1], 40
    s_load_dwordx2 s[8:9], s[0:1], 48
    s_mov_b32 s50, 0x21800000
    s_mov_b32 s51, 0x76800000
    s_mov_b32 s52, 0x12800000
    s_mov_b32 s53, 0x7e800000
    s_add_u32 s39, s43, 6291456
    s_nop 3
    v_add_f32_e64 v136, |v16|, |v17|
    v_add_f32_e64 v137, |v18|, |v19|
    v_add_f32_e64 v138, |v20|, |v21|
    v_add_f32_e64 v139, |v22|, |v23|
    v_add_f32 v136, v136, v137
    v_add_f32 v138, v138, v139
    v_add_f32 v136, v136, v138
    v_cmp_le_f32_e64 s[54:55], s50, v24
    v_cmp_ge_f32_e64 s[56:57], s51, v24
    v_cmp_le_f32_e64 s[58:59], s52, v136
    v_cmp_ge_f32_e64 s[60:61], s53, v136
    s_and_b64 s[54:55], s[54:55], s[56:57]
    s_and_b64 s[58:59], s[58:59], s[60:61]
    s_and_b64 s[54:55], s[54:55], s[58:59]
    s_cmp_eq_u64 s[54:55], -1
    s_cbranch_scc0 concat_heads__sliding_local_dilated__mha_block__prompt_kernel_fallback
concat_heads__sliding_local_dilated__mha_block__prompt_kernel_fin:
    v_rcp_f32 v136, v24
    s_nop 0
    v_mul_f32 v16, v16, v136
    v_mul_f32 v17, v17, v136
    v_mul_f32 v18, v18, v136
    v_mul_f32 v19, v19, v136
    v_mul_f32 v20, v20, v136
    v_mul_f32 v21, v21, v136
    v_mul_f32 v22, v22, v136
    v_mul_f32 v23, v23, v136
    v_cvt_pk_bf16_f32 v140, v16, v17
    v_cvt_pk_bf16_f32 v141, v18, v19
    v_cvt_pk_bf16_f32 v142, v20, v21
    v_cvt_pk_bf16_f32 v143, v22, v23
    buffer_store_dwordx4 v[140:143], v2, s[20:23], s39 offen sc1
    s_lshl_b32 s49, s30, 5
    s_add_u32 s49, s49, s28
    s_lshl_b32 s49, s49, 7
    s_add_u32 s10, s49, 16842752
    s_lshr_b32 s28, s26, 2
    s_and_b32 s29, s26, 3
    s_lshl_b32 s29, s29, 2
    s_and_b32 s34, s27, 3
    s_add_u32 s30, s29, s34
    s_lshr_b32 s31, s27, 2
    s_and_b32 s47, s33, 3
    s_lshr_b32 s48, s33, 2
    s_lshl_b32 s34, s30, 2
    s_add_u32 s34, s34, s47
    s_and_b32 s35, s47, 1
    s_lshl_b32 s36, s35, 5
    s_lshl_b32 s37, s30, 1
    s_add_u32 s36, s36, s37
    s_lshr_b32 s37, s47, 1
    s_add_u32 s36, s36, s37
    s_cmp_eq_u32 s28, 1
    s_cselect_b32 s34, s36, s34
    s_cselect_b32 s38, 6291456, 0
    s_cselect_b32 s39, 0, 14680064
    s_add_u32 s38, s38, s39
    s_lshl_b32 s34, s34, 10
    s_add_u32 s34, s34, s38
    s_lshl_b32 s38, s48, 20
    s_add_u32 s34, s34, s38
    v_lshrrev_b32 v136, 5, v1
    v_lshlrev_b32 v137, 2, v136
    v_bfe_u32 v138, v1, 2, 2
    v_add_u32 v137, v137, v138
    s_lshl_b32 s40, s47, 3
    s_lshl_b32 s42, s48, 5
    s_add_u32 s40, s40, s42
    s_and_b32 s40, s47, 1
    s_lshl_b32 s40, s40, 3
    s_lshl_b32 s53, s31, 1
    s_lshl_b32 s54, s48, 1
    s_lshr_b32 s42, s47, 1
    s_add_u32 s54, s54, s42
    s_add_u32 s54, s54, s53
    v_add_u32 v137, s40, v137
    v_lshlrev_b32 v137, 10, v137
    v_bfe_u32 v138, v1, 4, 1
    v_lshlrev_b32 v138, 6, v138
    v_and_b32 v139, 3, v1
    v_lshlrev_b32 v139, 4, v139
    v_add3_u32 v137, v137, v138, v139
    s_lshl_b32 s40, s31, 7
    v_add_u32 v8, s40, v137
    s_lshl_b32 s41, s47, 10
    s_lshl_b32 s42, s48, 12
    s_add_u32 s41, s41, s42
    v_lshlrev_b32 v137, 10, v136
    v_bfe_u32 v138, v1, 2, 2
    v_lshlrev_b32 v138, 6, v138
    v_and_b32 v139, 1, v1
    v_lshlrev_b32 v139, 5, v139
    v_add3_u32 v137, v137, v138, v139
    v_bfe_u32 v138, v1, 4, 1
    v_lshlrev_b32 v138, 4, v138
    v_bfe_u32 v139, v1, 1, 1
    v_lshlrev_b32 v139, 3, v139
    v_add3_u32 v137, v137, v138, v139
    s_lshl_b32 s42, s48, 15
    v_add_u32 v137, s42, v137
    s_lshl_b32 s42, s48, 8
    v_add_u32 v9, s42, v137
    s_xor_b32 s42, s42, 256
    v_add_u32 v10, s42, v137
    v_and_b32 v137, 31, v1
    s_lshl_b32 s43, s30, 7
    s_lshl_b32 s44, s47, 5
    s_lshr_b32 s45, s47, 1
    s_lshl_b32 s45, s45, 6
    s_and_b32 s46, s47, 1
    s_add_u32 s45, s45, s46
    s_cmp_eq_u32 s28, 1
    s_cselect_b32 s44, s45, s44
    s_cselect_b32 s46, 12, 11
    s_cselect_b32 s45, 0, 1024
    s_add_u32 s43, s43, s44
    s_lshl_b32 s43, s43, 11
    s_add_u32 s43, s43, s45
    s_lshl_b32 s45, s31, 7
    s_add_u32 s43, s43, s45
    s_lshl_b32 s45, s48, 6
    s_add_u32 s43, s43, s45
    v_lshlrev_b32 v137, s46, v137
    v_lshlrev_b32 v138, 5, v136
    v_add3_u32 v11, v137, v138, s43
    v_and_b32 v137, 31, v1
    s_lshl_b32 s50, s47, 12
    s_add_u32 s50, s50, 98304
    v_lshlrev_b32 v138, 7, v137
    v_add_u32 v138, s50, v138
    v_lshlrev_b32 v139, 1, v136
    s_lshl_b32 s50, s48, 2
    v_add_u32 v139, s50, v139
    v_and_b32 v137, 7, v137
    v_xor_b32 v139, v139, v137
    v_lshlrev_b32 v144, 4, v139
    v_add_u32 v14, v138, v144
    v_xor_b32 v144, 16, v144
    v_add_u32 v15, v138, v144
    v_lshrrev_b32 v137, 3, v1
    v_and_b32 v138, 7, v1
    v_xor_b32 v139, v138, v137
    v_lshlrev_b32 v139, 4, v139
    v_lshlrev_b32 v144, 7, v137
    s_lshl_b32 s50, s33, 11
    s_add_u32 s50, s50, 98304
    v_add3_u32 v3, v139, v144, s50
    s_lshl_b32 s50, s33, 4
    s_lshr_b32 s51, s33, 2
    s_lshl_b32 s51, s51, 6
    s_bfe_u32 s52, s33, 0x10001
    s_add_u32 s51, s51, s52
    s_and_b32 s52, s33, 1
    s_lshl_b32 s52, s52, 5
    s_add_u32 s51, s51, s52
    s_cmp_eq_u32 s28, 1
    s_cselect_b32 s50, s51, s50
    s_cselect_b32 s51, 0, 1024
    s_lshl_b32 s52, s30, 7
    s_add_u32 s50, s50, s52
    s_lshl_b32 s50, s50, 11
    s_add_u32 s50, s50, s51
    s_lshl_b32 s51, s31, 7
    s_add_u32 s50, s50, s51
    v_lshlrev_b32 v137, s46, v137
    v_lshlrev_b32 v138, 4, v138
    v_add3_u32 v11, v137, v138, s50
    s_lshl_b32 s50, 8, s46
    v_and_b32 v137, 31, v1
    v_lshlrev_b32 v137, 7, v137
    s_lshr_b32 s45, s30, 1
    s_lshl_b32 s45, s45, 12
    s_add_u32 s45, s45, 16842752
    v_add_u32 v155, s45, v137
    s_lshl_b32 s45, s47, 1
    s_add_u32 s46, s45, s48
    s_xor_b32 s45, s46, 1
    s_lshl_b32 s46, s46, 12
    s_lshl_b32 s45, s45, 12
    s_add_u32 s46, s46, 65536
    s_add_u32 s45, s45, 65536
    v_add_u32 v12, s45, v2
    v_add_u32 v13, s46, v2
    s_waitcnt lgkmcnt(0)
    s_cmp_eq_u32 s28, 1
    s_cselect_b32 s12, s4, s6
    s_cselect_b32 s13, s5, s7
    s_mov_b32 s14, 524288
    s_mov_b32 s15, 0x00020000
    s_mov_b32 s16, s8
    s_mov_b32 s17, s9
    s_mov_b32 s18, 4194304
    s_mov_b32 s19, 0x00020000
    s_waitcnt vmcnt(0)
    s_barrier
    s_cmp_eq_u32 s33, 7
    s_cbranch_scc0 concat_heads__sliding_local_dilated__mha_block__prompt_kernel_noft
    v_mov_b32 v136, s3
    v_mov_b32 v137, s10
    s_mov_b64 exec, 1
    buffer_store_dword v136, v137, s[20:23], 0 offen sc1
    s_mov_b64 exec, -1
concat_heads__sliding_local_dilated__mha_block__prompt_kernel_noft:
    s_add_u32 m0, s41, 0
    s_add_u32 s42, s54, 0
    s_and_b32 s42, s42, 15
    s_lshl_b32 s42, s42, 14
    buffer_load_dwordx4 v8, s[12:15], s42 offen lds
    s_add_u32 m0, s41, 8192
    s_add_u32 s42, s54, 4
    s_and_b32 s42, s42, 15
    s_lshl_b32 s42, s42, 14
    buffer_load_dwordx4 v8, s[12:15], s42 offen lds
    s_add_u32 m0, s41, 16384
    s_add_u32 s42, s54, 8
    s_and_b32 s42, s42, 15
    s_lshl_b32 s42, s42, 14
    buffer_load_dwordx4 v8, s[12:15], s42 offen lds
    s_add_u32 m0, s41, 24576
    s_add_u32 s42, s54, 12
    s_and_b32 s42, s42, 15
    s_lshl_b32 s42, s42, 14
    buffer_load_dwordx4 v8, s[12:15], s42 offen lds
    s_add_u32 m0, s41, 32768
    s_add_u32 s42, s54, 0
    s_and_b32 s42, s42, 15
    s_lshl_b32 s42, s42, 14
    s_add_u32 s42, s42, 262144
    buffer_load_dwordx4 v8, s[12:15], s42 offen lds
    s_add_u32 m0, s41, 40960
    s_add_u32 s42, s54, 4
    s_and_b32 s42, s42, 15
    s_lshl_b32 s42, s42, 14
    s_add_u32 s42, s42, 262144
    buffer_load_dwordx4 v8, s[12:15], s42 offen lds
    s_add_u32 m0, s41, 49152
    s_add_u32 s42, s54, 8
    s_and_b32 s42, s42, 15
    s_lshl_b32 s42, s42, 14
    s_add_u32 s42, s42, 262144
    buffer_load_dwordx4 v8, s[12:15], s42 offen lds
    s_add_u32 m0, s41, 57344
    s_add_u32 s42, s54, 12
    s_and_b32 s42, s42, 15
    s_lshl_b32 s42, s42, 14
    s_add_u32 s42, s42, 262144
    buffer_load_dwordx4 v8, s[12:15], s42 offen lds
    s_cmp_eq_u32 s33, 7
    s_cbranch_scc0 concat_heads__sliding_local_dilated__mha_block__prompt_kernel_z2
    s_mov_b32 s51, 0
concat_heads__sliding_local_dilated__mha_block__prompt_kernel_poll4:
    buffer_load_dword v136, v155, s[20:23], 0 offen sc1
concat_heads__sliding_local_dilated__mha_block__prompt_kernel_poll4_chk:
    s_waitcnt vmcnt(0)
    v_cmp_ne_u32 vcc, s3, v136
    s_cbranch_vccz concat_heads__sliding_local_dilated__mha_block__prompt_kernel_poll4_ok
    s_add_u32 s51, s51, 1
    s_cmp_lt_u32 s51, 32768
    s_cbranch_scc1 concat_heads__sliding_local_dilated__mha_block__prompt_kernel_poll4
concat_heads__sliding_local_dilated__mha_block__prompt_kernel_poll4_ok:
concat_heads__sliding_local_dilated__mha_block__prompt_kernel_z2:
    s_waitcnt vmcnt(0)
    s_barrier
    s_add_u32 s42, s53, 0
    s_and_b32 s42, s42, 15
    s_lshl_b32 s42, s42, 16
    s_add_u32 s42, s42, s34
    buffer_load_dwordx4 v[160:163], v2, s[20:23], s42 offen sc1
    s_add_u32 s42, s53, 1
    s_and_b32 s42, s42, 15
    s_lshl_b32 s42, s42, 16
    s_add_u32 s42, s42, s34
    buffer_load_dwordx4 v[164:167], v2, s[20:23], s42 offen sc1
    s_add_u32 s42, s53, 2
    s_and_b32 s42, s42, 15
    s_lshl_b32 s42, s42, 16
    s_add_u32 s42, s42, s34
    buffer_load_dwordx4 v[168:171], v2, s[20:23], s42 offen sc1
    s_add_u32 s42, s53, 3
    s_and_b32 s42, s42, 15
    s_lshl_b32 s42, s42, 16
    s_add_u32 s42, s42, s34
    buffer_load_dwordx4 v[172:175], v2, s[20:23], s42 offen sc1
    s_add_u32 s42, s53, 4
    s_and_b32 s42, s42, 15
    s_lshl_b32 s42, s42, 16
    s_add_u32 s42, s42, s34
    buffer_load_dwordx4 v[176:179], v2, s[20:23], s42 offen sc1
    s_add_u32 s42, s53, 5
    s_and_b32 s42, s42, 15
    s_lshl_b32 s42, s42, 16
    s_add_u32 s42, s42, s34
    buffer_load_dwordx4 v[180:183], v2, s[20:23], s42 offen sc1
    s_add_u32 s42, s53, 6
    s_and_b32 s42, s42, 15
    s_lshl_b32 s42, s42, 16
    s_add_u32 s42, s42, s34
    buffer_load_dwordx4 v[184:187], v2, s[20:23], s42 offen sc1
    s_add_u32 s42, s53, 7
    s_and_b32 s42, s42, 15
    s_lshl_b32 s42, s42, 16
    s_add_u32 s42, s42, s34
    buffer_load_dwordx4 v[188:191], v2, s[20:23], s42 offen sc1
    s_add_u32 s42, s53, 8
    s_and_b32 s42, s42, 15
    s_lshl_b32 s42, s42, 16
    s_add_u32 s42, s42, s34
    buffer_load_dwordx4 v[192:195], v2, s[20:23], s42 offen sc1
    s_add_u32 s42, s53, 9
    s_and_b32 s42, s42, 15
    s_lshl_b32 s42, s42, 16
    s_add_u32 s42, s42, s34
    buffer_load_dwordx4 v[196:199], v2, s[20:23], s42 offen sc1
    s_add_u32 s42, s53, 10
    s_and_b32 s42, s42, 15
    s_lshl_b32 s42, s42, 16
    s_add_u32 s42, s42, s34
    buffer_load_dwordx4 v[200:203], v2, s[20:23], s42 offen sc1
    s_add_u32 s42, s53, 11
    s_and_b32 s42, s42, 15
    s_lshl_b32 s42, s42, 16
    s_add_u32 s42, s42, s34
    buffer_load_dwordx4 v[204:207], v2, s[20:23], s42 offen sc1
    s_add_u32 s42, s53, 12
    s_and_b32 s42, s42, 15
    s_lshl_b32 s42, s42, 16
    s_add_u32 s42, s42, s34
    buffer_load_dwordx4 v[208:211], v2, s[20:23], s42 offen sc1
    s_add_u32 s42, s53, 13
    s_and_b32 s42, s42, 15
    s_lshl_b32 s42, s42, 16
    s_add_u32 s42, s42, s34
    buffer_load_dwordx4 v[212:215], v2, s[20:23], s42 offen sc1
    s_add_u32 s42, s53, 14
    s_and_b32 s42, s42, 15
    s_lshl_b32 s42, s42, 16
    s_add_u32 s42, s42, s34
    buffer_load_dwordx4 v[216:219], v2, s[20:23], s42 offen sc1
    s_add_u32 s42, s53, 15
    s_and_b32 s42, s42, 15
    s_lshl_b32 s42, s42, 16
    s_add_u32 s42, s42, s34
    buffer_load_dwordx4 v[220:223], v2, s[20:23], s42 offen sc1
    ds_read_b64_tr_b16 v[64:65], v9 offset:0
    ds_read_b64_tr_b16 v[66:67], v9 offset:512
    ds_read_b64_tr_b16 v[68:69], v10 offset:0
    ds_read_b64_tr_b16 v[70:71], v10 offset:512
    ds_read_b64_tr_b16 v[72:73], v9 offset:2048
    ds_read_b64_tr_b16 v[74:75], v9 offset:2560
    ds_read_b64_tr_b16 v[76:77], v10 offset:2048
    ds_read_b64_tr_b16 v[78:79], v10 offset:2560
    s_waitcnt vmcnt(15) lgkmcnt(6)
    v_mfma_f32_32x32x16_bf16 v[32:47], v[64:67], v[160:163], 0
    s_waitcnt lgkmcnt(4)
    v_mfma_f32_32x32x16_bf16 v[48:63], v[68:71], v[160:163], 0
    ds_read_b64_tr_b16 v[64:65], v9 offset:4096
    ds_read_b64_tr_b16 v[66:67], v9 offset:4608
    ds_read_b64_tr_b16 v[68:69], v10 offset:4096
    ds_read_b64_tr_b16 v[70:71], v10 offset:4608
    s_waitcnt vmcnt(14) lgkmcnt(6)
    v_mfma_f32_32x32x16_bf16 v[32:47], v[72:75], v[164:167], v[32:47]
    s_waitcnt lgkmcnt(4)
    v_mfma_f32_32x32x16_bf16 v[48:63], v[76:79], v[164:167], v[48:63]
    ds_read_b64_tr_b16 v[72:73], v9 offset:6144
    ds_read_b64_tr_b16 v[74:75], v9 offset:6656
    ds_read_b64_tr_b16 v[76:77], v10 offset:6144
    ds_read_b64_tr_b16 v[78:79], v10 offset:6656
    s_waitcnt vmcnt(13) lgkmcnt(6)
    v_mfma_f32_32x32x16_bf16 v[32:47], v[64:67], v[168:171], v[32:47]
    s_waitcnt lgkmcnt(4)
    v_mfma_f32_32x32x16_bf16 v[48:63], v[68:71], v[168:171], v[48:63]
    ds_read_b64_tr_b16 v[64:65], v9 offset:8192
    ds_read_b64_tr_b16 v[66:67], v9 offset:8704
    ds_read_b64_tr_b16 v[68:69], v10 offset:8192
    ds_read_b64_tr_b16 v[70:71], v10 offset:8704
    s_waitcnt vmcnt(12) lgkmcnt(6)
    v_mfma_f32_32x32x16_bf16 v[32:47], v[72:75], v[172:175], v[32:47]
    s_waitcnt lgkmcnt(4)
    v_mfma_f32_32x32x16_bf16 v[48:63], v[76:79], v[172:175], v[48:63]
    ds_read_b64_tr_b16 v[72:73], v9 offset:10240
    ds_read_b64_tr_b16 v[74:75], v9 offset:10752
    ds_read_b64_tr_b16 v[76:77], v10 offset:10240
    ds_read_b64_tr_b16 v[78:79], v10 offset:10752
    s_waitcnt vmcnt(11) lgkmcnt(6)
    v_mfma_f32_32x32x16_bf16 v[32:47], v[64:67], v[176:179], v[32:47]
    s_waitcnt lgkmcnt(4)
    v_mfma_f32_32x32x16_bf16 v[48:63], v[68:71], v[176:179], v[48:63]
    ds_read_b64_tr_b16 v[64:65], v9 offset:12288
    ds_read_b64_tr_b16 v[66:67], v9 offset:12800
    ds_read_b64_tr_b16 v[68:69], v10 offset:12288
    ds_read_b64_tr_b16 v[70:71], v10 offset:12800
    s_waitcnt vmcnt(10) lgkmcnt(6)
    v_mfma_f32_32x32x16_bf16 v[32:47], v[72:75], v[180:183], v[32:47]
    s_waitcnt lgkmcnt(4)
    v_mfma_f32_32x32x16_bf16 v[48:63], v[76:79], v[180:183], v[48:63]
    ds_read_b64_tr_b16 v[72:73], v9 offset:14336
    ds_read_b64_tr_b16 v[74:75], v9 offset:14848
    ds_read_b64_tr_b16 v[76:77], v10 offset:14336
    ds_read_b64_tr_b16 v[78:79], v10 offset:14848
    s_waitcnt vmcnt(9) lgkmcnt(6)
    v_mfma_f32_32x32x16_bf16 v[32:47], v[64:67], v[184:187], v[32:47]
    s_waitcnt lgkmcnt(4)
    v_mfma_f32_32x32x16_bf16 v[48:63], v[68:71], v[184:187], v[48:63]
    ds_read_b64_tr_b16 v[64:65], v9 offset:16384
    ds_read_b64_tr_b16 v[66:67], v9 offset:16896
    ds_read_b64_tr_b16 v[68:69], v10 offset:16384
    ds_read_b64_tr_b16 v[70:71], v10 offset:16896
    s_waitcnt vmcnt(8) lgkmcnt(6)
    v_mfma_f32_32x32x16_bf16 v[32:47], v[72:75], v[188:191], v[32:47]
    s_waitcnt lgkmcnt(4)
    v_mfma_f32_32x32x16_bf16 v[48:63], v[76:79], v[188:191], v[48:63]
    ds_read_b64_tr_b16 v[72:73], v9 offset:18432
    ds_read_b64_tr_b16 v[74:75], v9 offset:18944
    ds_read_b64_tr_b16 v[76:77], v10 offset:18432
    ds_read_b64_tr_b16 v[78:79], v10 offset:18944
    s_waitcnt vmcnt(7) lgkmcnt(6)
    v_mfma_f32_32x32x16_bf16 v[32:47], v[64:67], v[192:195], v[32:47]
    s_waitcnt lgkmcnt(4)
    v_mfma_f32_32x32x16_bf16 v[48:63], v[68:71], v[192:195], v[48:63]
    ds_read_b64_tr_b16 v[64:65], v9 offset:20480
    ds_read_b64_tr_b16 v[66:67], v9 offset:20992
    ds_read_b64_tr_b16 v[68:69], v10 offset:20480
    ds_read_b64_tr_b16 v[70:71], v10 offset:20992
    s_waitcnt vmcnt(6) lgkmcnt(6)
    v_mfma_f32_32x32x16_bf16 v[32:47], v[72:75], v[196:199], v[32:47]
    s_waitcnt lgkmcnt(4)
    v_mfma_f32_32x32x16_bf16 v[48:63], v[76:79], v[196:199], v[48:63]
    ds_read_b64_tr_b16 v[72:73], v9 offset:22528
    ds_read_b64_tr_b16 v[74:75], v9 offset:23040
    ds_read_b64_tr_b16 v[76:77], v10 offset:22528
    ds_read_b64_tr_b16 v[78:79], v10 offset:23040
    s_waitcnt vmcnt(5) lgkmcnt(6)
    v_mfma_f32_32x32x16_bf16 v[32:47], v[64:67], v[200:203], v[32:47]
    s_waitcnt lgkmcnt(4)
    v_mfma_f32_32x32x16_bf16 v[48:63], v[68:71], v[200:203], v[48:63]
    ds_read_b64_tr_b16 v[64:65], v9 offset:24576
    ds_read_b64_tr_b16 v[66:67], v9 offset:25088
    ds_read_b64_tr_b16 v[68:69], v10 offset:24576
    ds_read_b64_tr_b16 v[70:71], v10 offset:25088
    s_waitcnt vmcnt(4) lgkmcnt(6)
    v_mfma_f32_32x32x16_bf16 v[32:47], v[72:75], v[204:207], v[32:47]
    s_waitcnt lgkmcnt(4)
    v_mfma_f32_32x32x16_bf16 v[48:63], v[76:79], v[204:207], v[48:63]
    ds_read_b64_tr_b16 v[72:73], v9 offset:26624
    ds_read_b64_tr_b16 v[74:75], v9 offset:27136
    ds_read_b64_tr_b16 v[76:77], v10 offset:26624
    ds_read_b64_tr_b16 v[78:79], v10 offset:27136
    s_waitcnt vmcnt(3) lgkmcnt(6)
    v_mfma_f32_32x32x16_bf16 v[32:47], v[64:67], v[208:211], v[32:47]
    s_waitcnt lgkmcnt(4)
    v_mfma_f32_32x32x16_bf16 v[48:63], v[68:71], v[208:211], v[48:63]
    ds_read_b64_tr_b16 v[64:65], v9 offset:28672
    ds_read_b64_tr_b16 v[66:67], v9 offset:29184
    ds_read_b64_tr_b16 v[68:69], v10 offset:28672
    ds_read_b64_tr_b16 v[70:71], v10 offset:29184
    s_waitcnt vmcnt(2) lgkmcnt(6)
    v_mfma_f32_32x32x16_bf16 v[32:47], v[72:75], v[212:215], v[32:47]
    s_waitcnt lgkmcnt(4)
    v_mfma_f32_32x32x16_bf16 v[48:63], v[76:79], v[212:215], v[48:63]
    ds_read_b64_tr_b16 v[72:73], v9 offset:30720
    ds_read_b64_tr_b16 v[74:75], v9 offset:31232
    ds_read_b64_tr_b16 v[76:77], v10 offset:30720
    ds_read_b64_tr_b16 v[78:79], v10 offset:31232
    s_waitcnt vmcnt(1) lgkmcnt(6)
    v_mfma_f32_32x32x16_bf16 v[32:47], v[64:67], v[216:219], v[32:47]
    s_waitcnt lgkmcnt(4)
    v_mfma_f32_32x32x16_bf16 v[48:63], v[68:71], v[216:219], v[48:63]
    s_waitcnt vmcnt(0) lgkmcnt(2)
    v_mfma_f32_32x32x16_bf16 v[32:47], v[72:75], v[220:223], v[32:47]
    s_waitcnt lgkmcnt(0)
    v_mfma_f32_32x32x16_bf16 v[48:63], v[76:79], v[220:223], v[48:63]
    s_nop 7
    s_nop 3
    ds_write_b128 v12, v[48:51] offset:0
    ds_write_b128 v12, v[52:55] offset:1024
    ds_write_b128 v12, v[56:59] offset:2048
    ds_write_b128 v12, v[60:63] offset:3072
    s_waitcnt lgkmcnt(0)
    s_barrier
    ds_read_b128 v[64:67], v13 offset:0
    ds_read_b128 v[68:71], v13 offset:1024
    ds_read_b128 v[72:75], v13 offset:2048
    ds_read_b128 v[76:79], v13 offset:3072
    s_waitcnt lgkmcnt(3)
    v_add_f32 v32, v32, v64
    v_add_f32 v33, v33, v65
    v_add_f32 v34, v34, v66
    v_add_f32 v35, v35, v67
    s_waitcnt lgkmcnt(2)
    v_add_f32 v36, v36, v68
    v_add_f32 v37, v37, v69
    v_add_f32 v38, v38, v70
    v_add_f32 v39, v39, v71
    s_waitcnt lgkmcnt(1)
    v_add_f32 v40, v40, v72
    v_add_f32 v41, v41, v73
    v_add_f32 v42, v42, v74
    v_add_f32 v43, v43, v75
    s_waitcnt lgkmcnt(0)
    v_add_f32 v44, v44, v76
    v_add_f32 v45, v45, v77
    v_add_f32 v46, v46, v78
    v_add_f32 v47, v47, v79
    v_cvt_pk_bf16_f32 v80, v32, v33
    v_cvt_pk_bf16_f32 v81, v34, v35
    v_cvt_pk_bf16_f32 v82, v36, v37
    v_cvt_pk_bf16_f32 v83, v38, v39
    v_cvt_pk_bf16_f32 v84, v40, v41
    v_cvt_pk_bf16_f32 v85, v42, v43
    v_cvt_pk_bf16_f32 v86, v44, v45
    v_cvt_pk_bf16_f32 v87, v46, v47
    ds_write_b128 v14, v[80:83]
    ds_write_b128 v15, v[84:87]
    s_waitcnt lgkmcnt(0)
    s_barrier
    ds_read_b128 v[88:91], v3
    ds_read_b128 v[92:95], v3 offset:1024
    s_waitcnt lgkmcnt(1)
    buffer_store_dwordx4 v[88:91], v11, s[16:19], 0 offen sc0 sc1
    s_waitcnt lgkmcnt(0)
    buffer_store_dwordx4 v[92:95], v11, s[16:19], s50 offen sc0 sc1
concat_heads__sliding_local_dilated__mha_block__prompt_kernel_end:
    s_endpgm
concat_heads__sliding_local_dilated__mha_block__prompt_kernel_fallback:
    v_mov_b32 v154, 0xff800000
    v_mov_b32 v137, v109
    s_mov_b32 s40, 0
concat_heads__sliding_local_dilated__mha_block__prompt_kernel_fb1:
    ds_read_b128 v[80:83], v137
    v_add_u32 v137, 1024, v137
    s_waitcnt lgkmcnt(0)
    v_mfma_f32_32x32x16_bf16 v[32:47], v[80:83], v[4:7], 0
    s_nop 7
    s_nop 3
    v_max3_f32 v154, v154, v32, v33
    v_max3_f32 v154, v154, v34, v35
    v_max3_f32 v154, v154, v36, v37
    v_max3_f32 v154, v154, v38, v39
    v_max3_f32 v154, v154, v40, v41
    v_max3_f32 v154, v154, v42, v43
    v_max3_f32 v154, v154, v44, v45
    v_max3_f32 v154, v154, v46, v47
    s_add_u32 s40, s40, 1
    s_cmp_lt_u32 s40, 64
    s_cbranch_scc1 concat_heads__sliding_local_dilated__mha_block__prompt_kernel_fb1
    v_mov_b32 v136, v154
    s_nop 1
    v_permlane32_swap_b32 v136, v154
    v_max_f32 v154, v154, v136
    v_mov_b32 v137, v109
    v_mov_b32 v138, v110
    v_mov_b32 v139, v111
    s_mov_b32 s40, 0
    v_mov_b32 v16, 0
    v_mov_b32 v17, 0
    v_mov_b32 v18, 0
    v_mov_b32 v19, 0
    v_mov_b32 v20, 0
    v_mov_b32 v21, 0
    v_mov_b32 v22, 0
    v_mov_b32 v23, 0
    v_mov_b32 v24, 0
    v_mov_b32 v25, 0
    v_mov_b32 v26, 0
    v_mov_b32 v27, 0
    v_mov_b32 v28, 0
    v_mov_b32 v29, 0
    v_mov_b32 v30, 0
    v_mov_b32 v31, 0
concat_heads__sliding_local_dilated__mha_block__prompt_kernel_fb2:
    ds_read_b128 v[80:83], v137
    s_mov_b64 exec, s[44:45]
    ds_read_b128 v[92:95], v138
    ds_read_b128 v[96:99], v139
    s_mov_b64 exec, -1
    v_add_u32 v137, 1024, v137
    v_add_u32 v138, 1024, v138
    v_add_u32 v139, 1024, v139
    s_waitcnt lgkmcnt(0)
    v_mfma_f32_32x32x16_bf16 v[32:47], v[80:83], v[4:7], 0
    s_nop 7
    s_nop 3
    v_sub_f32 v32, v32, v154
    v_sub_f32 v33, v33, v154
    v_sub_f32 v34, v34, v154
    v_sub_f32 v35, v35, v154
    v_sub_f32 v36, v36, v154
    v_sub_f32 v37, v37, v154
    v_sub_f32 v38, v38, v154
    v_sub_f32 v39, v39, v154
    v_sub_f32 v40, v40, v154
    v_sub_f32 v41, v41, v154
    v_sub_f32 v42, v42, v154
    v_sub_f32 v43, v43, v154
    v_sub_f32 v44, v44, v154
    v_sub_f32 v45, v45, v154
    v_sub_f32 v46, v46, v154
    v_sub_f32 v47, v47, v154
    v_exp_f32 v32, v32
    v_exp_f32 v33, v33
    v_exp_f32 v34, v34
    v_exp_f32 v35, v35
    v_exp_f32 v36, v36
    v_exp_f32 v37, v37
    v_exp_f32 v38, v38
    v_exp_f32 v39, v39
    v_exp_f32 v40, v40
    v_exp_f32 v41, v41
    v_exp_f32 v42, v42
    v_exp_f32 v43, v43
    v_exp_f32 v44, v44
    v_exp_f32 v45, v45
    v_exp_f32 v46, v46
    v_exp_f32 v47, v47
    s_nop 1
    v_smfmac_f32_32x32x32_bf16 v[16:31], v[92:95], v[32:39], v108
    v_smfmac_f32_32x32x32_bf16 v[16:31], v[96:99], v[40:47], v108
    s_nop 7
    s_nop 7
    s_add_u32 s40, s40, 1
    s_cmp_lt_u32 s40, 64
    s_cbranch_scc1 concat_heads__sliding_local_dilated__mha_block__prompt_kernel_fb2
    s_nop 7
    s_branch concat_heads__sliding_local_dilated__mha_block__prompt_kernel_fin
concat_heads__sliding_local_dilated__mha_block__prompt_kernel_codeend:
.section .rodata,"a"
.p2align 6
.amdhsa_kernel concat_heads__sliding_local_dilated__mha_block__prompt_kernel
  .amdhsa_next_free_vgpr 256
  .amdhsa_next_free_sgpr 72
  .amdhsa_accum_offset 256
  .amdhsa_group_segment_fixed_size 0
  .amdhsa_kernarg_size 72
  .amdhsa_user_sgpr_count 2
  .amdhsa_user_sgpr_kernarg_segment_ptr 1
  .amdhsa_system_sgpr_workgroup_id_x 1
.end_amdhsa_kernel
```
